```python
import torch

def _softmax(x, axis=-1):
    return torch.softmax(x, dim=axis)

def _gelu(x):
    return torch.nn.functional.gelu(x, approximate='tanh')

def _silu(x):
    return torch.nn.functional.silu(x)

def _sigmoid(x):
    return torch.sigmoid(x)

def _layernorm(x, axis=-1, eps=1e-05):
    m = x.mean(dim=axis, keepdim=True)
    v = x.var(dim=axis, keepdim=True, unbiased=False)
    return (x - m) / torch.sqrt(v + eps)

def _scatter_add(tgt, idx, src, axis=0):
    return tgt.clone().index_add_(axis, idx, src)

def _segment_sum(src, seg, n):
    out = torch.zeros((n,) + src.shape[1:], dtype=src.dtype)
    return out.index_add_(0, seg, src)

def _pad(x, pw):
    flat = tuple((v for pair in reversed(pw) for v in pair))
    return torch.nn.functional.pad(x, flat)
kernel_name = 'standalone__mm_dit__diffusion'

def setup_inputs():

    _w = lambda a: (lambda t: t.to(torch.bfloat16) if t.is_floating_point() else t)(torch.as_tensor(a))
    B, Ni, Nt, D = (2, 1024, 32, 768)
    return {'x_img': _w((lambda *s: torch.randn(*s, dtype=torch.bfloat16) * 0.05)(B, Ni, D)), 'x_txt': _w((lambda *s: torch.randn(*s, dtype=torch.bfloat16) * 0.05)(B, Nt, D)), 'c': _w((lambda *s: torch.randn(*s, dtype=torch.bfloat16) * 0.05)(B, D)), 'wqkv_img': _w((lambda *s: torch.randn(*s, dtype=torch.bfloat16) * 0.05)(D, 3 * D)), 'wqkv_txt': _w((lambda *s: torch.randn(*s, dtype=torch.bfloat16) * 0.05)(D, 3 * D)), 'wo_img': _w((lambda *s: torch.randn(*s, dtype=torch.bfloat16) * 0.05)(D, D)), 'wo_txt': _w((lambda *s: torch.randn(*s, dtype=torch.bfloat16) * 0.05)(D, D)), 'wmod_img': _w((lambda *s: torch.randn(*s, dtype=torch.bfloat16) * 0.05)(D, 6 * D)), 'wmod_txt': _w((lambda *s: torch.randn(*s, dtype=torch.bfloat16) * 0.05)(D, 6 * D))}

def reference(x_img, x_txt, c, wqkv_img, wqkv_txt, wo_img, wo_txt, wmod_img, wmod_txt):
    B, Ni, D = x_img.shape
    Nt = x_txt.shape[1]
    mod_i = (_silu(c) @ wmod_img).reshape(B, 6, 1, D)
    mod_t = (_silu(c) @ wmod_txt).reshape(B, 6, 1, D)
    shi, sci, gai = (mod_i[:, 0].clone(), mod_i[:, 1].clone(), mod_i[:, 2].clone())
    sht, sct, gat = (mod_t[:, 0].clone(), mod_t[:, 1].clone(), mod_t[:, 2].clone())
    hi = _layernorm(x_img, axis=-1) * (1 + sci) + shi
    ht = _layernorm(x_txt, axis=-1) * (1 + sct) + sht
    qkvi = hi @ wqkv_img
    qkvt = ht @ wqkv_txt
    qi, ki, vi = (qkvi[..., :D].clone(), qkvi[..., D:2 * D].clone(), qkvi[..., 2 * D:].clone())
    qt, kt, vt = (qkvt[..., :D].clone(), qkvt[..., D:2 * D].clone(), qkvt[..., 2 * D:].clone())
    q = torch.concatenate([qt, qi], axis=1)
    k = torch.concatenate([kt, ki], axis=1)
    v = torch.concatenate([vt, vi], axis=1)
    scores = torch.einsum('bqd,bkd->bqk', q, k) * D ** (-0.5)
    p = _softmax(scores, axis=-1)
    a = torch.einsum('bqk,bkd->bqd', p, v)
    at, ai = (a[:, :Nt].clone(), a[:, Nt:].clone())
    out_i = x_img + gai * (ai @ wo_img)
    out_t = x_txt + gat * (at @ wo_txt)
    return (out_i, out_t)
```

```asm
; @launch kernel=mod_kernel grid=(288,1,1) block=(256,1,1) lds=22528
; @launch kernel=ln_kernel grid=(133,1,1) block=(1024,1,1) lds=8192
; @launch kernel=qkv_kernel grid=(256,1,1) block=(512,1,1) lds=147456
; @launch kernel=sv_kernel grid=(232,1,1) block=(512,1,1) lds=147456
; @launch kernel=fo_kernel grid=(256,1,1) block=(512,1,1) lds=152064
.amdgcn_target "amdgcn-amd-amdhsa--gfx950"
.text
.globl mod_kernel
.p2align 8
.type mod_kernel,@function
mod_kernel:
    s_cmp_ge_u32 s2, 288
    s_cbranch_scc1 L_mod_end
    s_load_dwordx2 s[4:5], s[0:1], 16
    s_load_dwordx4 s[8:11], s[0:1], 56
    s_load_dwordx2 s[6:7], s[0:1], 88
    s_mul_hi_u32 s14, s2, 59652324
    s_mul_i32 s15, s14, 72
    s_sub_u32 s15, s2, s15
    v_lshrrev_b32 v1, 6, v0
    v_and_b32 v2, 63, v0
    v_lshrrev_b32 v3, 3, v2
    v_mul_u32_u24 v4, 48, v1
    v_add_u32 v4, v4, v3
    s_mul_i32 s21, s14, 192
    v_add_u32 v12, s21, v4
    v_mul_u32_u24 v5, 9216, v12
    v_and_b32 v6, 7, v2
    v_lshlrev_b32 v6, 4, v6
    v_add_u32 v5, v5, v6
    v_add_u32 v7, s21, v0
    v_lshlrev_b32 v7, 1, v7
    s_cmp_ge_u32 s15, 36
    s_cselect_b32 s16, 36, 0
    s_cselect_b32 s19, 18432, 0
    s_sub_u32 s17, s15, s16
    s_lshl_b32 s18, s17, 7
    s_waitcnt lgkmcnt(0)
    s_cmp_ge_u32 s15, 36
    s_cselect_b32 s12, s10, s8
    s_cselect_b32 s13, s11, s9

    s_mov_b32 s20, s12
    s_mov_b32 s21, s13
    s_mov_b32 s22, 7077888
    s_mov_b32 s23, 0x00020000
    s_mov_b32 s24, s4
    s_mov_b32 s25, s5
    s_mov_b32 s26, 3072
    s_mov_b32 s27, 0x00020000
    s_add_u32 s28, s6, 32505856
    s_addc_u32 s29, s7, 0
    s_mov_b32 s30, 147456
    s_mov_b32 s31, 0x00020000
    buffer_load_ushort v8, v7, s[24:27], 0 offen
    buffer_load_ushort v9, v7, s[24:27], 0 offen offset:1536

    buffer_load_dwordx4 v[16:19], v5, s[20:23], s18 offen nt
    s_add_u32 s18, s18, 73728
    buffer_load_dwordx4 v[20:23], v5, s[20:23], s18 offen nt
    s_add_u32 s18, s18, 73728
    buffer_load_dwordx4 v[24:27], v5, s[20:23], s18 offen nt
    s_add_u32 s18, s18, 73728
    buffer_load_dwordx4 v[28:31], v5, s[20:23], s18 offen nt
    s_add_u32 s18, s18, 73728
    buffer_load_dwordx4 v[32:35], v5, s[20:23], s18 offen nt
    s_add_u32 s18, s18, 73728
    buffer_load_dwordx4 v[36:39], v5, s[20:23], s18 offen nt
    s_waitcnt vmcnt(6)
    v_lshlrev_b32 v8, 16, v8
    v_lshlrev_b32 v9, 16, v9
    v_mul_f32 v10, 0xbfb8aa3b, v8
    v_mul_f32 v11, 0xbfb8aa3b, v9
    v_exp_f32 v10, v10
    v_exp_f32 v11, v11
    s_nop 0
    v_add_f32 v10, 1.0, v10
    v_add_f32 v11, 1.0, v11
    v_rcp_f32 v10, v10
    v_rcp_f32 v11, v11
    s_nop 0
    v_mul_f32 v8, v8, v10
    v_mul_f32 v9, v9, v11
    v_cvt_pk_bf16_f32 v10, v8, v9
    v_lshlrev_b32 v8, 16, v10
    v_and_b32 v9, 0xffff0000, v10
    v_lshlrev_b32 v12, 3, v0
    v_cmp_gt_u32 vcc, 192, v0
    s_and_saveexec_b64 s[32:33], vcc
    ds_write_b64 v12, v[8:9]
    s_mov_b64 exec, s[32:33]
    s_waitcnt lgkmcnt(0)
    s_barrier
    v_lshlrev_b32 v13, 3, v4

    ds_read_b64 v[40:41], v13 offset:0
    ds_read_b64 v[42:43], v13 offset:64
    ds_read_b64 v[44:45], v13 offset:128
    ds_read_b64 v[46:47], v13 offset:192
    ds_read_b64 v[48:49], v13 offset:256
    ds_read_b64 v[50:51], v13 offset:320
    v_mov_b32 v56, 0
    v_mov_b32 v57, 0
    v_mov_b32 v58, 0
    v_mov_b32 v59, 0
    v_mov_b32 v60, 0
    v_mov_b32 v61, 0
    v_mov_b32 v62, 0
    v_mov_b32 v63, 0
    v_mov_b32 v64, 0
    v_mov_b32 v65, 0
    v_mov_b32 v66, 0
    v_mov_b32 v67, 0
    v_mov_b32 v68, 0
    v_mov_b32 v69, 0
    v_mov_b32 v70, 0
    v_mov_b32 v71, 0
    v_lshlrev_b32 v74, 4, v0
    s_getpc_b64 s[60:61]
L_mod_pc:
    s_add_u32 s60, s60, L_code_begin_next-L_mod_pc
    s_addc_u32 s61, s61, 0
    s_lshr_b32 s62, s2, 3
    s_lshl_b32 s62, s62, 12
    v_add_u32 v75, s62, v74
    v_min_u32 v75, CODE_BYTES-16, v75
    global_load_dwordx4 v[80:83], v75, s[60:61]
    s_waitcnt lgkmcnt(0)
    s_waitcnt vmcnt(6)
    v_lshlrev_b32 v72, 16, v16
    v_and_b32 v73, 0xffff0000, v16
    v_fmac_f32 v56, v40, v72
    v_fmac_f32 v57, v40, v73
    v_fmac_f32 v64, v41, v72
    v_fmac_f32 v65, v41, v73
    v_lshlrev_b32 v72, 16, v17
    v_and_b32 v73, 0xffff0000, v17
    v_fmac_f32 v58, v40, v72
    v_fmac_f32 v59, v40, v73
    v_fmac_f32 v66, v41, v72
    v_fmac_f32 v67, v41, v73
    v_lshlrev_b32 v72, 16, v18
    v_and_b32 v73, 0xffff0000, v18
    v_fmac_f32 v60, v40, v72
    v_fmac_f32 v61, v40, v73
    v_fmac_f32 v68, v41, v72
    v_fmac_f32 v69, v41, v73
    v_lshlrev_b32 v72, 16, v19
    v_and_b32 v73, 0xffff0000, v19
    v_fmac_f32 v62, v40, v72
    v_fmac_f32 v63, v40, v73
    v_fmac_f32 v70, v41, v72
    v_fmac_f32 v71, v41, v73
    s_waitcnt vmcnt(5)
    v_lshlrev_b32 v72, 16, v20
    v_and_b32 v73, 0xffff0000, v20
    v_fmac_f32 v56, v42, v72
    v_fmac_f32 v57, v42, v73
    v_fmac_f32 v64, v43, v72
    v_fmac_f32 v65, v43, v73
    v_lshlrev_b32 v72, 16, v21
    v_and_b32 v73, 0xffff0000, v21
    v_fmac_f32 v58, v42, v72
    v_fmac_f32 v59, v42, v73
    v_fmac_f32 v66, v43, v72
    v_fmac_f32 v67, v43, v73
    v_lshlrev_b32 v72, 16, v22
    v_and_b32 v73, 0xffff0000, v22
    v_fmac_f32 v60, v42, v72
    v_fmac_f32 v61, v42, v73
    v_fmac_f32 v68, v43, v72
    v_fmac_f32 v69, v43, v73
    v_lshlrev_b32 v72, 16, v23
    v_and_b32 v73, 0xffff0000, v23
    v_fmac_f32 v62, v42, v72
    v_fmac_f32 v63, v42, v73
    v_fmac_f32 v70, v43, v72
    v_fmac_f32 v71, v43, v73
    s_waitcnt vmcnt(4)
    v_lshlrev_b32 v72, 16, v24
    v_and_b32 v73, 0xffff0000, v24
    v_fmac_f32 v56, v44, v72
    v_fmac_f32 v57, v44, v73
    v_fmac_f32 v64, v45, v72
    v_fmac_f32 v65, v45, v73
    v_lshlrev_b32 v72, 16, v25
    v_and_b32 v73, 0xffff0000, v25
    v_fmac_f32 v58, v44, v72
    v_fmac_f32 v59, v44, v73
    v_fmac_f32 v66, v45, v72
    v_fmac_f32 v67, v45, v73
    v_lshlrev_b32 v72, 16, v26
    v_and_b32 v73, 0xffff0000, v26
    v_fmac_f32 v60, v44, v72
    v_fmac_f32 v61, v44, v73
    v_fmac_f32 v68, v45, v72
    v_fmac_f32 v69, v45, v73
    v_lshlrev_b32 v72, 16, v27
    v_and_b32 v73, 0xffff0000, v27
    v_fmac_f32 v62, v44, v72
    v_fmac_f32 v63, v44, v73
    v_fmac_f32 v70, v45, v72
    v_fmac_f32 v71, v45, v73
    s_waitcnt vmcnt(3)
    v_lshlrev_b32 v72, 16, v28
    v_and_b32 v73, 0xffff0000, v28
    v_fmac_f32 v56, v46, v72
    v_fmac_f32 v57, v46, v73
    v_fmac_f32 v64, v47, v72
    v_fmac_f32 v65, v47, v73
    v_lshlrev_b32 v72, 16, v29
    v_and_b32 v73, 0xffff0000, v29
    v_fmac_f32 v58, v46, v72
    v_fmac_f32 v59, v46, v73
    v_fmac_f32 v66, v47, v72
    v_fmac_f32 v67, v47, v73
    v_lshlrev_b32 v72, 16, v30
    v_and_b32 v73, 0xffff0000, v30
    v_fmac_f32 v60, v46, v72
    v_fmac_f32 v61, v46, v73
    v_fmac_f32 v68, v47, v72
    v_fmac_f32 v69, v47, v73
    v_lshlrev_b32 v72, 16, v31
    v_and_b32 v73, 0xffff0000, v31
    v_fmac_f32 v62, v46, v72
    v_fmac_f32 v63, v46, v73
    v_fmac_f32 v70, v47, v72
    v_fmac_f32 v71, v47, v73
    s_waitcnt vmcnt(2)
    v_lshlrev_b32 v72, 16, v32
    v_and_b32 v73, 0xffff0000, v32
    v_fmac_f32 v56, v48, v72
    v_fmac_f32 v57, v48, v73
    v_fmac_f32 v64, v49, v72
    v_fmac_f32 v65, v49, v73
    v_lshlrev_b32 v72, 16, v33
    v_and_b32 v73, 0xffff0000, v33
    v_fmac_f32 v58, v48, v72
    v_fmac_f32 v59, v48, v73
    v_fmac_f32 v66, v49, v72
    v_fmac_f32 v67, v49, v73
    v_lshlrev_b32 v72, 16, v34
    v_and_b32 v73, 0xffff0000, v34
    v_fmac_f32 v60, v48, v72
    v_fmac_f32 v61, v48, v73
    v_fmac_f32 v68, v49, v72
    v_fmac_f32 v69, v49, v73
    v_lshlrev_b32 v72, 16, v35
    v_and_b32 v73, 0xffff0000, v35
    v_fmac_f32 v62, v48, v72
    v_fmac_f32 v63, v48, v73
    v_fmac_f32 v70, v49, v72
    v_fmac_f32 v71, v49, v73
    s_waitcnt vmcnt(1)
    v_lshlrev_b32 v72, 16, v36
    v_and_b32 v73, 0xffff0000, v36
    v_fmac_f32 v56, v50, v72
    v_fmac_f32 v57, v50, v73
    v_fmac_f32 v64, v51, v72
    v_fmac_f32 v65, v51, v73
    v_lshlrev_b32 v72, 16, v37
    v_and_b32 v73, 0xffff0000, v37
    v_fmac_f32 v58, v50, v72
    v_fmac_f32 v59, v50, v73
    v_fmac_f32 v66, v51, v72
    v_fmac_f32 v67, v51, v73
    v_lshlrev_b32 v72, 16, v38
    v_and_b32 v73, 0xffff0000, v38
    v_fmac_f32 v60, v50, v72
    v_fmac_f32 v61, v50, v73
    v_fmac_f32 v68, v51, v72
    v_fmac_f32 v69, v51, v73
    v_lshlrev_b32 v72, 16, v39
    v_and_b32 v73, 0xffff0000, v39
    v_fmac_f32 v62, v50, v72
    v_fmac_f32 v63, v50, v73
    v_fmac_f32 v70, v51, v72
    v_fmac_f32 v71, v51, v73
    v_lshlrev_b32 v14, 3, v1
    v_add_u32 v14, v14, v3
    v_lshlrev_b32 v14, 9, v14
    v_lshlrev_b32 v15, 1, v6
    v_add_u32 v14, v14, v15
    ds_write_b128 v14, v[56:59] offset:2048
    ds_write_b128 v14, v[60:63] offset:2064
    ds_write_b128 v14, v[64:67] offset:2304
    ds_write_b128 v14, v[68:71] offset:2320
    s_waitcnt lgkmcnt(0)
    s_barrier
    v_and_b32 v3, 127, v0
    v_lshrrev_b32 v4, 7, v0
    v_lshlrev_b32 v5, 13, v4
    v_lshl_add_u32 v5, v3, 2, v5

    ds_read_b32 v16, v5 offset:2048
    ds_read_b32 v17, v5 offset:2560
    ds_read_b32 v18, v5 offset:3072
    ds_read_b32 v19, v5 offset:3584
    ds_read_b32 v20, v5 offset:4096
    ds_read_b32 v21, v5 offset:4608
    ds_read_b32 v22, v5 offset:5120
    ds_read_b32 v23, v5 offset:5632
    ds_read_b32 v24, v5 offset:6144
    ds_read_b32 v25, v5 offset:6656
    ds_read_b32 v26, v5 offset:7168
    ds_read_b32 v27, v5 offset:7680
    ds_read_b32 v28, v5 offset:8192
    ds_read_b32 v29, v5 offset:8704
    ds_read_b32 v30, v5 offset:9216
    ds_read_b32 v31, v5 offset:9728
    s_waitcnt lgkmcnt(0)
    v_add_f32 v16, v16, v24
    v_add_f32 v17, v17, v25
    v_add_f32 v18, v18, v26
    v_add_f32 v19, v19, v27
    v_add_f32 v20, v20, v28
    v_add_f32 v21, v21, v29
    v_add_f32 v22, v22, v30
    v_add_f32 v23, v23, v31
    v_add_f32 v16, v16, v20
    v_add_f32 v17, v17, v21
    v_add_f32 v18, v18, v22
    v_add_f32 v19, v19, v23
    v_add_f32 v16, v16, v18
    v_add_f32 v17, v17, v19
    v_add_f32 v16, v16, v17
    v_lshlrev_b32 v6, 2, v0
    ds_write_b32 v6, v16 offset:20480
    s_waitcnt lgkmcnt(0)
    s_barrier
    v_cmp_gt_u32 vcc, 128, v0
    s_and_saveexec_b64 s[32:33], vcc
    s_cbranch_execz L_mod_end
    ds_read_b32 v17, v6 offset:20992
    s_waitcnt lgkmcnt(0)
    v_add_f32 v16, v16, v17
    v_lshrrev_b32 v17, 6, v0
    v_mul_u32_u24 v17, 9216, v17
    v_and_b32 v18, 63, v0
    v_lshl_add_u32 v17, v18, 2, v17
    s_lshl_b32 s20, s17, 8
    s_add_u32 s20, s20, s19
    s_mul_i32 s21, s14, 36864
    s_add_u32 s20, s20, s21
    buffer_store_dword v16, v17, s[28:31], s20 offen
L_mod_end:
    s_endpgm

L_code_begin_next:
.globl ln_kernel
.p2align 8
.type ln_kernel,@function
ln_kernel:
    s_cmp_ge_u32 s2, 133
    s_cbranch_scc1 L_ln_end
    s_load_dwordx4 s[4:7], s[0:1], 0
    s_load_dwordx2 s[8:9], s[0:1], 88
    v_lshrrev_b32 v1, 6, v0
    v_and_b32 v2, 63, v0
    s_nop 0
    v_readfirstlane_b32 s12, v1
    s_cmp_eq_u32 s2, 132
    s_cbranch_scc1 L_ln_gate
    s_lshl_b32 s13, s2, 4
    s_add_u32 s13, s13, s12
    s_cmp_ge_u32 s13, 2048
    s_cselect_b32 s14, 2048, 0
    s_cselect_b32 s15, 5, 10
    s_cselect_b32 s16, 18432, 0
    s_sub_u32 s17, s13, s14
    s_lshr_b32 s18, s17, s15
    s_mul_i32 s18, s18, 9216
    s_add_u32 s18, s18, s16
    s_mul_i32 s19, s17, 1536
    s_lshl_b32 s13, s13, 7
    v_lshlrev_b32 v3, 3, v2
    v_lshlrev_b32 v4, 4, v2
    v_lshlrev_b32 v5, 2, v0
    s_waitcnt lgkmcnt(0)
    s_cmp_ge_u32 s14, 1
    s_cselect_b32 s20, s6, s4
    s_cselect_b32 s21, s7, s5
    s_mov_b32 s22, 3145728
    s_cselect_b32 s22, 98304, s22
    s_mov_b32 s23, 0x00020000

    s_add_u32 s24, s8, 32505856
    s_addc_u32 s25, s9, 0
    s_mov_b32 s26, 147456
    s_mov_b32 s27, 0x00020000
    s_add_u32 s28, s8, 65536
    s_addc_u32 s29, s9, 0
    s_mov_b32 s30, 3244032
    s_mov_b32 s31, 0x00020000
    buffer_load_dwordx2 v[8:9], v3, s[20:23], s19 offen offset:0
    buffer_load_dwordx2 v[10:11], v3, s[20:23], s19 offen offset:512
    buffer_load_dwordx2 v[12:13], v3, s[20:23], s19 offen offset:1024
    s_add_u32 s34, s18, 0
    buffer_load_dword v60, v5, s[24:27], s34 offen
    s_add_u32 s35, s34, 4096
    buffer_load_dword v64, v5, s[24:27], s35 offen
    s_add_u32 s34, s18, 36864
    buffer_load_dword v61, v5, s[24:27], s34 offen
    s_add_u32 s35, s34, 4096
    buffer_load_dword v65, v5, s[24:27], s35 offen
    s_add_u32 s34, s18, 73728
    buffer_load_dword v62, v5, s[24:27], s34 offen
    s_add_u32 s35, s34, 4096
    buffer_load_dword v66, v5, s[24:27], s35 offen
    s_add_u32 s34, s18, 110592
    buffer_load_dword v63, v5, s[24:27], s34 offen
    s_add_u32 s35, s34, 4096
    buffer_load_dword v67, v5, s[24:27], s35 offen
    v_lshlrev_b32 v70, 4, v0
    s_waitcnt vmcnt(0)
    v_add_f32 v60, v60, v61
    v_add_f32 v62, v62, v63
    v_add_f32 v60, v60, v62
    v_add_f32 v64, v64, v65
    v_add_f32 v66, v66, v67
    v_add_f32 v64, v64, v66
    v_cvt_pk_bf16_f32 v61, v60, v64
    v_lshlrev_b32 v60, 16, v61
    v_and_b32 v64, 0xffff0000, v61
    ds_write_b32 v5, v60
    v_cmp_gt_u32 vcc, 512, v0
    s_and_saveexec_b64 s[32:33], vcc
    ds_write_b32 v5, v64 offset:4096
    s_mov_b64 exec, s[32:33]

    v_lshlrev_b32 v40, 16, v8
    v_and_b32 v41, 0xffff0000, v8
    v_lshlrev_b32 v42, 16, v9
    v_and_b32 v43, 0xffff0000, v9
    v_lshlrev_b32 v44, 16, v10
    v_and_b32 v45, 0xffff0000, v10
    v_lshlrev_b32 v46, 16, v11
    v_and_b32 v47, 0xffff0000, v11
    v_lshlrev_b32 v48, 16, v12
    v_and_b32 v49, 0xffff0000, v12
    v_lshlrev_b32 v50, 16, v13
    v_and_b32 v51, 0xffff0000, v13
    v_add_f32 v52, v40, v41
    v_add_f32 v52, v52, v42
    v_add_f32 v52, v52, v43
    v_add_f32 v52, v52, v44
    v_add_f32 v52, v52, v45
    v_add_f32 v52, v52, v46
    v_add_f32 v52, v52, v47
    v_add_f32 v52, v52, v48
    v_add_f32 v52, v52, v49
    v_add_f32 v52, v52, v50
    v_add_f32 v52, v52, v51
    s_nop 1
    v_add_f32_dpp v52, v52, v52 quad_perm:[1,0,3,2] row_mask:0xf bank_mask:0xf
    s_nop 1
    v_add_f32_dpp v52, v52, v52 quad_perm:[2,3,0,1] row_mask:0xf bank_mask:0xf
    s_nop 1
    v_add_f32_dpp v52, v52, v52 row_half_mirror row_mask:0xf bank_mask:0xf
    s_nop 1
    v_add_f32_dpp v52, v52, v52 row_mirror row_mask:0xf bank_mask:0xf
    v_mov_b32 v53, v52
    v_mov_b32 v54, v52
    s_nop 1
    v_permlane16_swap_b32 v53, v54
    s_nop 0
    v_add_f32 v52, v53, v54
    v_mov_b32 v53, v52
    v_mov_b32 v54, v52
    s_nop 1
    v_permlane32_swap_b32 v53, v54
    s_nop 0
    v_add_f32 v52, v53, v54
    v_mul_f32 v52, 0x3aaaaaab, v52
    v_mov_b32 v55, 0
    v_sub_f32 v56, v40, v52
    v_fmac_f32 v55, v56, v56
    v_sub_f32 v56, v41, v52
    v_fmac_f32 v55, v56, v56
    v_sub_f32 v56, v42, v52
    v_fmac_f32 v55, v56, v56
    v_sub_f32 v56, v43, v52
    v_fmac_f32 v55, v56, v56
    v_sub_f32 v56, v44, v52
    v_fmac_f32 v55, v56, v56
    v_sub_f32 v56, v45, v52
    v_fmac_f32 v55, v56, v56
    v_sub_f32 v56, v46, v52
    v_fmac_f32 v55, v56, v56
    v_sub_f32 v56, v47, v52
    v_fmac_f32 v55, v56, v56
    v_sub_f32 v56, v48, v52
    v_fmac_f32 v55, v56, v56
    v_sub_f32 v56, v49, v52
    v_fmac_f32 v55, v56, v56
    v_sub_f32 v56, v50, v52
    v_fmac_f32 v55, v56, v56
    v_sub_f32 v56, v51, v52
    v_fmac_f32 v55, v56, v56
    s_nop 1
    v_add_f32_dpp v55, v55, v55 quad_perm:[1,0,3,2] row_mask:0xf bank_mask:0xf
    s_nop 1
    v_add_f32_dpp v55, v55, v55 quad_perm:[2,3,0,1] row_mask:0xf bank_mask:0xf
    s_nop 1
    v_add_f32_dpp v55, v55, v55 row_half_mirror row_mask:0xf bank_mask:0xf
    s_nop 1
    v_add_f32_dpp v55, v55, v55 row_mirror row_mask:0xf bank_mask:0xf
    v_mov_b32 v53, v55
    v_mov_b32 v54, v55
    s_nop 1
    v_permlane16_swap_b32 v53, v54
    s_nop 0
    v_add_f32 v55, v53, v54
    v_mov_b32 v53, v55
    v_mov_b32 v54, v55
    s_nop 1
    v_permlane32_swap_b32 v53, v54
    s_nop 0
    v_add_f32 v55, v53, v54
    v_mul_f32 v55, 0x3aaaaaab, v55
    v_cvt_pk_bf16_f32 v53, v52, v55
    v_lshlrev_b32 v52, 16, v53
    v_and_b32 v55, 0xffff0000, v53
    v_add_f32 v55, 0x3727c5ac, v55
    v_cvt_pk_bf16_f32 v53, v55, v55
    v_lshlrev_b32 v55, 16, v53
    v_and_b32 v55, 0xffff0000, v53
    v_sqrt_f32 v55, v55
    s_nop 0
    v_cvt_pk_bf16_f32 v53, v55, v55
    v_lshlrev_b32 v55, 16, v53
    v_and_b32 v55, 0xffff0000, v53
    v_rcp_f32 v55, v55
    s_waitcnt lgkmcnt(0)
    s_barrier
    ds_read_b128 v[16:19], v4 offset:0
    ds_read_b128 v[28:31], v4 offset:3072
    ds_read_b128 v[20:23], v4 offset:1024
    ds_read_b128 v[32:35], v4 offset:4096
    ds_read_b128 v[24:27], v4 offset:2048
    ds_read_b128 v[36:39], v4 offset:5120
    v_sub_f32 v40, v40, v52
    v_sub_f32 v41, v41, v52
    v_cvt_pk_bf16_f32 v53, v40, v41
    v_lshlrev_b32 v40, 16, v53
    v_and_b32 v41, 0xffff0000, v53
    v_mul_f32 v40, v40, v55
    v_mul_f32 v41, v41, v55
    v_cvt_pk_bf16_f32 v53, v40, v41
    v_lshlrev_b32 v40, 16, v53
    v_and_b32 v41, 0xffff0000, v53
    v_sub_f32 v42, v42, v52
    v_sub_f32 v43, v43, v52
    v_cvt_pk_bf16_f32 v53, v42, v43
    v_lshlrev_b32 v42, 16, v53
    v_and_b32 v43, 0xffff0000, v53
    v_mul_f32 v42, v42, v55
    v_mul_f32 v43, v43, v55
    v_cvt_pk_bf16_f32 v53, v42, v43
    v_lshlrev_b32 v42, 16, v53
    v_and_b32 v43, 0xffff0000, v53
    v_sub_f32 v44, v44, v52
    v_sub_f32 v45, v45, v52
    v_cvt_pk_bf16_f32 v53, v44, v45
    v_lshlrev_b32 v44, 16, v53
    v_and_b32 v45, 0xffff0000, v53
    v_mul_f32 v44, v44, v55
    v_mul_f32 v45, v45, v55
    v_cvt_pk_bf16_f32 v53, v44, v45
    v_lshlrev_b32 v44, 16, v53
    v_and_b32 v45, 0xffff0000, v53
    v_sub_f32 v46, v46, v52
    v_sub_f32 v47, v47, v52
    v_cvt_pk_bf16_f32 v53, v46, v47
    v_lshlrev_b32 v46, 16, v53
    v_and_b32 v47, 0xffff0000, v53
    v_mul_f32 v46, v46, v55
    v_mul_f32 v47, v47, v55
    v_cvt_pk_bf16_f32 v53, v46, v47
    v_lshlrev_b32 v46, 16, v53
    v_and_b32 v47, 0xffff0000, v53
    v_sub_f32 v48, v48, v52
    v_sub_f32 v49, v49, v52
    v_cvt_pk_bf16_f32 v53, v48, v49
    v_lshlrev_b32 v48, 16, v53
    v_and_b32 v49, 0xffff0000, v53
    v_mul_f32 v48, v48, v55
    v_mul_f32 v49, v49, v55
    v_cvt_pk_bf16_f32 v53, v48, v49
    v_lshlrev_b32 v48, 16, v53
    v_and_b32 v49, 0xffff0000, v53
    v_sub_f32 v50, v50, v52
    v_sub_f32 v51, v51, v52
    v_cvt_pk_bf16_f32 v53, v50, v51
    v_lshlrev_b32 v50, 16, v53
    v_and_b32 v51, 0xffff0000, v53
    v_mul_f32 v50, v50, v55
    v_mul_f32 v51, v51, v55
    v_cvt_pk_bf16_f32 v53, v50, v51
    v_lshlrev_b32 v50, 16, v53
    v_and_b32 v51, 0xffff0000, v53
    s_waitcnt lgkmcnt(0)
    v_add_f32 v28, 1.0, v28
    v_add_f32 v29, 1.0, v29
    v_cvt_pk_bf16_f32 v53, v28, v29
    v_lshlrev_b32 v28, 16, v53
    v_and_b32 v29, 0xffff0000, v53
    v_mul_f32 v40, v40, v28
    v_mul_f32 v41, v41, v29
    v_cvt_pk_bf16_f32 v53, v40, v41
    v_lshlrev_b32 v40, 16, v53
    v_and_b32 v41, 0xffff0000, v53
    v_add_f32 v40, v40, v16
    v_add_f32 v41, v41, v17
    v_cvt_pk_bf16_f32 v8, v40, v41
    v_add_f32 v30, 1.0, v30
    v_add_f32 v31, 1.0, v31
    v_cvt_pk_bf16_f32 v53, v30, v31
    v_lshlrev_b32 v30, 16, v53
    v_and_b32 v31, 0xffff0000, v53
    v_mul_f32 v42, v42, v30
    v_mul_f32 v43, v43, v31
    v_cvt_pk_bf16_f32 v53, v42, v43
    v_lshlrev_b32 v42, 16, v53
    v_and_b32 v43, 0xffff0000, v53
    v_add_f32 v42, v42, v18
    v_add_f32 v43, v43, v19
    v_cvt_pk_bf16_f32 v9, v42, v43
    v_add_f32 v32, 1.0, v32
    v_add_f32 v33, 1.0, v33
    v_cvt_pk_bf16_f32 v53, v32, v33
    v_lshlrev_b32 v32, 16, v53
    v_and_b32 v33, 0xffff0000, v53
    v_mul_f32 v44, v44, v32
    v_mul_f32 v45, v45, v33
    v_cvt_pk_bf16_f32 v53, v44, v45
    v_lshlrev_b32 v44, 16, v53
    v_and_b32 v45, 0xffff0000, v53
    v_add_f32 v44, v44, v20
    v_add_f32 v45, v45, v21
    v_cvt_pk_bf16_f32 v10, v44, v45
    v_add_f32 v34, 1.0, v34
    v_add_f32 v35, 1.0, v35
    v_cvt_pk_bf16_f32 v53, v34, v35
    v_lshlrev_b32 v34, 16, v53
    v_and_b32 v35, 0xffff0000, v53
    v_mul_f32 v46, v46, v34
    v_mul_f32 v47, v47, v35
    v_cvt_pk_bf16_f32 v53, v46, v47
    v_lshlrev_b32 v46, 16, v53
    v_and_b32 v47, 0xffff0000, v53
    v_add_f32 v46, v46, v22
    v_add_f32 v47, v47, v23
    v_cvt_pk_bf16_f32 v11, v46, v47
    v_add_f32 v36, 1.0, v36
    v_add_f32 v37, 1.0, v37
    v_cvt_pk_bf16_f32 v53, v36, v37
    v_lshlrev_b32 v36, 16, v53
    v_and_b32 v37, 0xffff0000, v53
    v_mul_f32 v48, v48, v36
    v_mul_f32 v49, v49, v37
    v_cvt_pk_bf16_f32 v53, v48, v49
    v_lshlrev_b32 v48, 16, v53
    v_and_b32 v49, 0xffff0000, v53
    v_add_f32 v48, v48, v24
    v_add_f32 v49, v49, v25
    v_cvt_pk_bf16_f32 v12, v48, v49
    v_add_f32 v38, 1.0, v38
    v_add_f32 v39, 1.0, v39
    v_cvt_pk_bf16_f32 v53, v38, v39
    v_lshlrev_b32 v38, 16, v53
    v_and_b32 v39, 0xffff0000, v53
    v_mul_f32 v50, v50, v38
    v_mul_f32 v51, v51, v39
    v_cvt_pk_bf16_f32 v53, v50, v51
    v_lshlrev_b32 v50, 16, v53
    v_and_b32 v51, 0xffff0000, v53
    v_add_f32 v50, v50, v26
    v_add_f32 v51, v51, v27
    v_cvt_pk_bf16_f32 v13, v50, v51
    v_lshrrev_b32 v6, 4, v2
    s_mov_b32 s36, 270336
    v_mul_lo_u32 v6, v6, s36
    v_and_b32 v7, 15, v2
    v_lshl_add_u32 v6, v7, 3, v6
    buffer_store_dwordx2 v[8:9], v6, s[28:31], s13 offen
    s_add_u32 s13, s13, 1081344
    buffer_store_dwordx2 v[10:11], v6, s[28:31], s13 offen
    s_add_u32 s13, s13, 1081344
    buffer_store_dwordx2 v[12:13], v6, s[28:31], s13 offen
    s_endpgm
L_ln_gate:
    v_lshlrev_b32 v5, 2, v0
    s_waitcnt lgkmcnt(0)

    s_add_u32 s24, s8, 32505856
    s_addc_u32 s25, s9, 0
    s_mov_b32 s26, 147456
    s_mov_b32 s27, 0x00020000
    s_mov_b32 s28, s8
    s_mov_b32 s29, s9
    s_mov_b32 s30, 36864
    s_mov_b32 s31, 0x00020000
    s_mov_b32 s34, 0
    buffer_load_dword v8, v5, s[24:27], s34 offen
    s_mov_b32 s34, 36864
    buffer_load_dword v9, v5, s[24:27], s34 offen
    s_mov_b32 s34, 73728
    buffer_load_dword v10, v5, s[24:27], s34 offen
    s_mov_b32 s34, 110592
    buffer_load_dword v11, v5, s[24:27], s34 offen
    s_mov_b32 s34, 4096
    buffer_load_dword v12, v5, s[24:27], s34 offen
    s_mov_b32 s34, 40960
    buffer_load_dword v13, v5, s[24:27], s34 offen
    s_mov_b32 s34, 77824
    buffer_load_dword v14, v5, s[24:27], s34 offen
    s_mov_b32 s34, 114688
    buffer_load_dword v15, v5, s[24:27], s34 offen
    s_mov_b32 s34, 8192
    buffer_load_dword v16, v5, s[24:27], s34 offen
    s_mov_b32 s34, 45056
    buffer_load_dword v17, v5, s[24:27], s34 offen
    s_mov_b32 s34, 81920
    buffer_load_dword v18, v5, s[24:27], s34 offen
    s_mov_b32 s34, 118784
    buffer_load_dword v19, v5, s[24:27], s34 offen
    s_mov_b32 s34, 12288
    buffer_load_dword v20, v5, s[24:27], s34 offen
    s_mov_b32 s34, 49152
    buffer_load_dword v21, v5, s[24:27], s34 offen
    s_mov_b32 s34, 86016
    buffer_load_dword v22, v5, s[24:27], s34 offen
    s_mov_b32 s34, 122880
    buffer_load_dword v23, v5, s[24:27], s34 offen
    s_mov_b32 s34, 16384
    buffer_load_dword v24, v5, s[24:27], s34 offen
    s_mov_b32 s34, 53248
    buffer_load_dword v25, v5, s[24:27], s34 offen
    s_mov_b32 s34, 90112
    buffer_load_dword v26, v5, s[24:27], s34 offen
    s_mov_b32 s34, 126976
    buffer_load_dword v27, v5, s[24:27], s34 offen
    s_mov_b32 s34, 20480
    buffer_load_dword v28, v5, s[24:27], s34 offen
    s_mov_b32 s34, 57344
    buffer_load_dword v29, v5, s[24:27], s34 offen
    s_mov_b32 s34, 94208
    buffer_load_dword v30, v5, s[24:27], s34 offen
    s_mov_b32 s34, 131072
    buffer_load_dword v31, v5, s[24:27], s34 offen
    s_mov_b32 s34, 24576
    buffer_load_dword v32, v5, s[24:27], s34 offen
    s_mov_b32 s34, 61440
    buffer_load_dword v33, v5, s[24:27], s34 offen
    s_mov_b32 s34, 98304
    buffer_load_dword v34, v5, s[24:27], s34 offen
    s_mov_b32 s34, 135168
    buffer_load_dword v35, v5, s[24:27], s34 offen
    s_mov_b32 s34, 28672
    buffer_load_dword v36, v5, s[24:27], s34 offen
    s_mov_b32 s34, 65536
    buffer_load_dword v37, v5, s[24:27], s34 offen
    s_mov_b32 s34, 102400
    buffer_load_dword v38, v5, s[24:27], s34 offen
    s_mov_b32 s34, 139264
    buffer_load_dword v39, v5, s[24:27], s34 offen
    s_mov_b32 s34, 32768
    buffer_load_dword v40, v5, s[24:27], s34 offen
    s_mov_b32 s34, 69632
    buffer_load_dword v41, v5, s[24:27], s34 offen
    s_mov_b32 s34, 106496
    buffer_load_dword v42, v5, s[24:27], s34 offen
    s_mov_b32 s34, 143360
    buffer_load_dword v43, v5, s[24:27], s34 offen
    s_waitcnt vmcnt(0)
    v_add_f32 v8, v8, v9
    v_add_f32 v10, v10, v11
    v_add_f32 v8, v8, v10
    v_cvt_pk_bf16_f32 v8, v8, v8
    v_lshlrev_b32 v8, 16, v8
    s_mov_b32 s34, 0
    buffer_store_dword v8, v5, s[28:31], s34 offen
    v_add_f32 v12, v12, v13
    v_add_f32 v14, v14, v15
    v_add_f32 v12, v12, v14
    v_cvt_pk_bf16_f32 v12, v12, v12
    v_lshlrev_b32 v12, 16, v12
    s_mov_b32 s34, 4096
    buffer_store_dword v12, v5, s[28:31], s34 offen
    v_add_f32 v16, v16, v17
    v_add_f32 v18, v18, v19
    v_add_f32 v16, v16, v18
    v_cvt_pk_bf16_f32 v16, v16, v16
    v_lshlrev_b32 v16, 16, v16
    s_mov_b32 s34, 8192
    buffer_store_dword v16, v5, s[28:31], s34 offen
    v_add_f32 v20, v20, v21
    v_add_f32 v22, v22, v23
    v_add_f32 v20, v20, v22
    v_cvt_pk_bf16_f32 v20, v20, v20
    v_lshlrev_b32 v20, 16, v20
    s_mov_b32 s34, 12288
    buffer_store_dword v20, v5, s[28:31], s34 offen
    v_add_f32 v24, v24, v25
    v_add_f32 v26, v26, v27
    v_add_f32 v24, v24, v26
    v_cvt_pk_bf16_f32 v24, v24, v24
    v_lshlrev_b32 v24, 16, v24
    s_mov_b32 s34, 16384
    buffer_store_dword v24, v5, s[28:31], s34 offen
    v_add_f32 v28, v28, v29
    v_add_f32 v30, v30, v31
    v_add_f32 v28, v28, v30
    v_cvt_pk_bf16_f32 v28, v28, v28
    v_lshlrev_b32 v28, 16, v28
    s_mov_b32 s34, 20480
    buffer_store_dword v28, v5, s[28:31], s34 offen
    v_add_f32 v32, v32, v33
    v_add_f32 v34, v34, v35
    v_add_f32 v32, v32, v34
    v_cvt_pk_bf16_f32 v32, v32, v32
    v_lshlrev_b32 v32, 16, v32
    s_mov_b32 s34, 24576
    buffer_store_dword v32, v5, s[28:31], s34 offen
    v_add_f32 v36, v36, v37
    v_add_f32 v38, v38, v39
    v_add_f32 v36, v36, v38
    v_cvt_pk_bf16_f32 v36, v36, v36
    v_lshlrev_b32 v36, 16, v36
    s_mov_b32 s34, 28672
    buffer_store_dword v36, v5, s[28:31], s34 offen
    v_add_f32 v40, v40, v41
    v_add_f32 v42, v42, v43
    v_add_f32 v40, v40, v42
    v_cvt_pk_bf16_f32 v40, v40, v40
    v_lshlrev_b32 v40, 16, v40
    s_mov_b32 s34, 32768
    buffer_store_dword v40, v5, s[28:31], s34 offen
L_ln_end:
    s_endpgm

.globl qkv_kernel
.p2align 8
.type qkv_kernel,@function
qkv_kernel:
    s_cmp_ge_u32 s2, 256
    s_cbranch_scc1 L_qkv_kernel_end
    s_load_dwordx4 s[4:7], s[0:1], 24
    s_load_dwordx2 s[8:9], s[0:1], 88
    s_and_b32 s40, s2, 7
    s_lshr_b32 s41, s2, 3
    s_lshl_b32 s40, s40, 5
    s_add_u32 s40, s40, s41
    s_cmp_ge_u32 s40, 252
    s_cbranch_scc1 L_qkv_kernel_end
    s_mul_hi_u32 s41, s40, 51130564
    s_mul_i32 s42, s41, 84
    s_sub_u32 s42, s40, s42
    s_mul_hi_u32 s43, s42, 715827883
    s_mul_i32 s44, s43, 6
    s_sub_u32 s44, s42, s44
    s_mul_i32 s49, s44, 540672
    s_lshl_b32 s48, s41, 22
    s_mul_i32 s41, s41, 6
    s_add_u32 s44, s44, s41
    s_mul_i32 s45, s43, 160
    s_mov_b32 s46, 2047
    s_cmp_eq_u32 s43, 13
    s_cselect_b32 s45, 2048, s45
    s_cselect_b32 s46, 2111, s46
    s_lshl_b32 s47, s44, 8
    v_lshrrev_b32 v2, 6, v0
    v_and_b32 v1, 63, v0
    s_nop 0
    v_readfirstlane_b32 s36, v2
    s_nop 3
    s_cmp_ge_u32 s36, 4
    s_cbranch_scc1 L_qkv_kernel_loader
    v_lshrrev_b32 v2, 4, v1
    v_and_b32 v3, 15, v1
    s_lshr_b32 s76, s36, 1
    s_and_b32 s77, s36, 1
    s_mul_i32 s38, s76, 10240
    v_and_b32 v4, 7, v1
    v_xor_b32 v4, v4, v2
    v_lshlrev_b32 v4, 4, v4
    v_lshl_add_u32 v8, v3, 7, v4
    v_add_u32 v8, s38, v8
    v_and_b32 v4, 7, v1
    v_xor_b32 v4, v4, v2
    v_xor_b32 v4, 4, v4
    v_lshlrev_b32 v4, 4, v4
    v_lshl_add_u32 v9, v3, 7, v4
    v_add_u32 v9, s38, v9
    v_lshrrev_b32 v4, 1, v2
    v_lshlrev_b32 v4, 4, v4
    v_and_b32 v5, 1, v2
    v_lshl_add_u32 v4, v5, 2, v4
    v_lshrrev_b32 v6, 2, v3
    v_add_u32 v4, v4, v6
    v_lshl_add_u32 v6, v5, 2, v6
    s_mul_i32 s38, s77, 4
    s_add_u32 s39, s38, 0
    v_xor_b32 v10, s39, v6
    v_lshlrev_b32 v10, 5, v10
    v_mul_u32_u24 v7, 256, v4
    v_add_u32 v10, v10, v7
    v_and_b32 v7, 3, v1
    v_lshl_add_u32 v10, v7, 3, v10
    v_add_u32 v10, 20480, v10
    s_add_u32 s39, s38, 1
    v_xor_b32 v11, s39, v6
    v_lshlrev_b32 v11, 5, v11
    v_mul_u32_u24 v7, 256, v4
    v_add_u32 v11, v11, v7
    v_and_b32 v7, 3, v1
    v_lshl_add_u32 v11, v7, 3, v11
    v_add_u32 v11, 20480, v11
    s_add_u32 s39, s38, 2
    v_xor_b32 v12, s39, v6
    v_lshlrev_b32 v12, 5, v12
    v_mul_u32_u24 v7, 256, v4
    v_add_u32 v12, v12, v7
    v_and_b32 v7, 3, v1
    v_lshl_add_u32 v12, v7, 3, v12
    v_add_u32 v12, 20480, v12
    s_add_u32 s39, s38, 3
    v_xor_b32 v13, s39, v6
    v_lshlrev_b32 v13, 5, v13
    v_mul_u32_u24 v7, 256, v4
    v_add_u32 v13, v13, v7
    v_and_b32 v7, 3, v1
    v_lshl_add_u32 v13, v7, 3, v13
    v_add_u32 v13, 20480, v13
    v_mov_b32 v100, 0
    v_mov_b32 v101, 0
    v_mov_b32 v102, 0
    v_mov_b32 v103, 0
    v_mov_b32 v104, 0
    v_mov_b32 v105, 0
    v_mov_b32 v106, 0
    v_mov_b32 v107, 0
    v_mov_b32 v108, 0
    v_mov_b32 v109, 0
    v_mov_b32 v110, 0
    v_mov_b32 v111, 0
    v_mov_b32 v112, 0
    v_mov_b32 v113, 0
    v_mov_b32 v114, 0
    v_mov_b32 v115, 0
    v_mov_b32 v116, 0
    v_mov_b32 v117, 0
    v_mov_b32 v118, 0
    v_mov_b32 v119, 0
    v_mov_b32 v120, 0
    v_mov_b32 v121, 0
    v_mov_b32 v122, 0
    v_mov_b32 v123, 0
    v_mov_b32 v124, 0
    v_mov_b32 v125, 0
    v_mov_b32 v126, 0
    v_mov_b32 v127, 0
    v_mov_b32 v128, 0
    v_mov_b32 v129, 0
    v_mov_b32 v130, 0
    v_mov_b32 v131, 0
    v_mov_b32 v132, 0
    v_mov_b32 v133, 0
    v_mov_b32 v134, 0
    v_mov_b32 v135, 0
    v_mov_b32 v136, 0
    v_mov_b32 v137, 0
    v_mov_b32 v138, 0
    v_mov_b32 v139, 0
    v_mov_b32 v140, 0
    v_mov_b32 v141, 0
    v_mov_b32 v142, 0
    v_mov_b32 v143, 0
    v_mov_b32 v144, 0
    v_mov_b32 v145, 0
    v_mov_b32 v146, 0
    v_mov_b32 v147, 0
    v_mov_b32 v148, 0
    v_mov_b32 v149, 0
    v_mov_b32 v150, 0
    v_mov_b32 v151, 0
    v_mov_b32 v152, 0
    v_mov_b32 v153, 0
    v_mov_b32 v154, 0
    v_mov_b32 v155, 0
    v_mov_b32 v156, 0
    v_mov_b32 v157, 0
    v_mov_b32 v158, 0
    v_mov_b32 v159, 0
    v_mov_b32 v160, 0
    v_mov_b32 v161, 0
    v_mov_b32 v162, 0
    v_mov_b32 v163, 0
    v_mov_b32 v164, 0
    v_mov_b32 v165, 0
    v_mov_b32 v166, 0
    v_mov_b32 v167, 0
    v_mov_b32 v168, 0
    v_mov_b32 v169, 0
    v_mov_b32 v170, 0
    v_mov_b32 v171, 0
    v_mov_b32 v172, 0
    v_mov_b32 v173, 0
    v_mov_b32 v174, 0
    v_mov_b32 v175, 0
    v_mov_b32 v176, 0
    v_mov_b32 v177, 0
    v_mov_b32 v178, 0
    v_mov_b32 v179, 0
    s_waitcnt lgkmcnt(0)
    s_cmp_eq_u32 s43, 13
    s_cselect_b32 s10, s6, s4
    s_cselect_b32 s11, s7, s5
    s_add_u32 s12, s8, s48
    s_addc_u32 s13, s9, 0

    s_add_u32 s78, s43, s44
    s_mul_hi_u32 s79, s78, 715827883
    s_mul_i32 s79, s79, 6
    s_sub_u32 s78, s78, s79
    s_lshl_b32 s78, s78, 1

    s_mov_b32 s78, 0
    s_add_u32 s16, s8, 65536
    s_addc_u32 s17, s9, 0
    s_mov_b32 s18, 3244032
    s_mov_b32 s19, 0x00020000
    s_mov_b32 s20, s10
    s_mov_b32 s21, s11
    s_mov_b32 s22, 3538944
    s_mov_b32 s23, 0x00020000
    s_add_u32 s24, s12, 4259840
    s_addc_u32 s25, s13, 0
    s_mov_b32 s26, 3244032
    s_mov_b32 s27, 0x00020000
    s_mul_i32 s38, s77, 128
    v_and_b32 v180, 1, v2
    v_lshlrev_b32 v180, 5, v180
    v_lshrrev_b32 v182, 1, v2
    v_lshl_add_u32 v180, v182, 4, v180
    v_add_u32 v180, s38, v180
    v_lshlrev_b32 v181, 3, v2
    v_add_u32 v181, s38, v181
    s_mul_i32 s38, s77, 270208
    v_add_u32 v180, s38, v180
    s_mul_i32 s39, s76, 80
    s_add_u32 s39, s39, s45
    v_add_u32 v192, s39, v3
    v_cmp_le_u32 vcc, 1024, v192
    v_add_u32 v195, 32, v192
    v_add_u32 v193, 64, v192
    v_cndmask_b32 v195, v195, v193, vcc
    v_subrev_u32 v193, 2048, v192
    v_cmp_le_u32 vcc, 2080, v192
    v_add_u32 v194, 1024, v193
    s_nop 0
    v_cndmask_b32 v193, v193, v194, vcc
    v_cmp_le_u32 vcc, 2048, v192
    s_nop 1
    v_cndmask_b32 v195, v195, v193, vcc
    v_lshlrev_b32 v195, 7, v195
    v_add_u32 v195, v195, v180
    v_cmp_ge_u32 vcc, s46, v192
    v_mov_b32 v193, 0x7fffffff
    s_nop 0
    v_cndmask_b32 v195, v193, v195, vcc
    v_add_u32 v192, s39, v3
    v_add_u32 v192, 16, v192
    v_cmp_le_u32 vcc, 1024, v192
    v_add_u32 v196, 32, v192
    v_add_u32 v193, 64, v192
    v_cndmask_b32 v196, v196, v193, vcc
    v_subrev_u32 v193, 2048, v192
    v_cmp_le_u32 vcc, 2080, v192
    v_add_u32 v194, 1024, v193
    s_nop 0
    v_cndmask_b32 v193, v193, v194, vcc
    v_cmp_le_u32 vcc, 2048, v192
    s_nop 1
    v_cndmask_b32 v196, v196, v193, vcc
    v_lshlrev_b32 v196, 7, v196
    v_add_u32 v196, v196, v180
    v_cmp_ge_u32 vcc, s46, v192
    v_mov_b32 v193, 0x7fffffff
    s_nop 0
    v_cndmask_b32 v196, v193, v196, vcc
    v_add_u32 v192, s39, v3
    v_add_u32 v192, 32, v192
    v_cmp_le_u32 vcc, 1024, v192
    v_add_u32 v197, 32, v192
    v_add_u32 v193, 64, v192
    v_cndmask_b32 v197, v197, v193, vcc
    v_subrev_u32 v193, 2048, v192
    v_cmp_le_u32 vcc, 2080, v192
    v_add_u32 v194, 1024, v193
    s_nop 0
    v_cndmask_b32 v193, v193, v194, vcc
    v_cmp_le_u32 vcc, 2048, v192
    s_nop 1
    v_cndmask_b32 v197, v197, v193, vcc
    v_lshlrev_b32 v197, 7, v197
    v_add_u32 v197, v197, v180
    v_cmp_ge_u32 vcc, s46, v192
    v_mov_b32 v193, 0x7fffffff
    s_nop 0
    v_cndmask_b32 v197, v193, v197, vcc
    v_add_u32 v192, s39, v3
    v_add_u32 v192, 48, v192
    v_cmp_le_u32 vcc, 1024, v192
    v_add_u32 v198, 32, v192
    v_add_u32 v193, 64, v192
    v_cndmask_b32 v198, v198, v193, vcc
    v_subrev_u32 v193, 2048, v192
    v_cmp_le_u32 vcc, 2080, v192
    v_add_u32 v194, 1024, v193
    s_nop 0
    v_cndmask_b32 v193, v193, v194, vcc
    v_cmp_le_u32 vcc, 2048, v192
    s_nop 1
    v_cndmask_b32 v198, v198, v193, vcc
    v_lshlrev_b32 v198, 7, v198
    v_add_u32 v198, v198, v180
    v_cmp_ge_u32 vcc, s46, v192
    v_mov_b32 v193, 0x7fffffff
    s_nop 0
    v_cndmask_b32 v198, v193, v198, vcc
    v_add_u32 v192, s39, v3
    v_add_u32 v192, 64, v192
    v_cmp_le_u32 vcc, 1024, v192
    v_add_u32 v199, 32, v192
    v_add_u32 v193, 64, v192
    v_cndmask_b32 v199, v199, v193, vcc
    v_subrev_u32 v193, 2048, v192
    v_cmp_le_u32 vcc, 2080, v192
    v_add_u32 v194, 1024, v193
    s_nop 0
    v_cndmask_b32 v193, v193, v194, vcc
    v_cmp_le_u32 vcc, 2048, v192
    s_nop 1
    v_cndmask_b32 v199, v199, v193, vcc
    v_lshlrev_b32 v199, 7, v199
    v_add_u32 v199, v199, v180
    v_cmp_ge_u32 vcc, s46, v192
    v_mov_b32 v193, 0x7fffffff
    s_nop 0
    v_cndmask_b32 v199, v193, v199, vcc
    s_mov_b32 s70, 0
    s_mov_b32 s71, 0
    v_add_u32 v14, s70, v8
    v_add_u32 v15, s70, v9
    v_add_u32 v16, s71, v8
    v_add_u32 v17, s70, v10
    v_add_u32 v18, s70, v11
    v_add_u32 v19, s70, v12
    v_add_u32 v20, s70, v13
    v_add_u32 v21, s71, v10
    v_add_u32 v22, s71, v11
    v_add_u32 v23, s71, v12
    v_add_u32 v24, s71, v13
    s_barrier
    ds_read_b128 v[28:31], v16 offset:0
    ds_read_b128 v[32:35], v16 offset:2048
    ds_read_b128 v[36:39], v16 offset:4096
    ds_read_b128 v[40:43], v16 offset:6144
    ds_read_b128 v[44:47], v16 offset:8192
    ds_read_b64_tr_b16 v[68:69], v21 offset:0
    ds_read_b64_tr_b16 v[70:71], v21 offset:2048
    ds_read_b64_tr_b16 v[72:73], v22 offset:0
    ds_read_b64_tr_b16 v[74:75], v22 offset:2048
    ds_read_b64_tr_b16 v[76:77], v23 offset:0
    ds_read_b64_tr_b16 v[78:79], v23 offset:2048
    ds_read_b64_tr_b16 v[80:81], v24 offset:0
    ds_read_b64_tr_b16 v[82:83], v24 offset:2048
    s_mov_b32 s71, 36864
    s_mov_b32 s74, 0
L_qkv_kernel_cl:
    s_barrier
    v_add_u32 v14, s70, v8
    v_add_u32 v15, s70, v9
    v_add_u32 v16, s71, v8
    v_add_u32 v17, s70, v10
    v_add_u32 v18, s70, v11
    v_add_u32 v19, s70, v12
    v_add_u32 v20, s70, v13
    v_add_u32 v21, s71, v10
    v_add_u32 v22, s71, v11
    v_add_u32 v23, s71, v12
    v_add_u32 v24, s71, v13
    s_waitcnt lgkmcnt(0)
    v_mfma_f32_16x16x32_bf16 v[100:103], v[68:71], v[28:31], v[100:103]
    ds_read_b128 v[48:51], v15 offset:0
    v_mfma_f32_16x16x32_bf16 v[104:107], v[72:75], v[28:31], v[104:107]
    ds_read_b128 v[52:55], v15 offset:2048
    v_mfma_f32_16x16x32_bf16 v[108:111], v[76:79], v[28:31], v[108:111]
    v_mfma_f32_16x16x32_bf16 v[112:115], v[80:83], v[28:31], v[112:115]
    ds_read_b128 v[56:59], v15 offset:4096
    v_mfma_f32_16x16x32_bf16 v[116:119], v[68:71], v[32:35], v[116:119]
    ds_read_b128 v[60:63], v15 offset:6144
    v_mfma_f32_16x16x32_bf16 v[120:123], v[72:75], v[32:35], v[120:123]
    v_mfma_f32_16x16x32_bf16 v[124:127], v[76:79], v[32:35], v[124:127]
    ds_read_b128 v[64:67], v15 offset:8192
    v_mfma_f32_16x16x32_bf16 v[128:131], v[80:83], v[32:35], v[128:131]
    ds_read_b64_tr_b16 v[84:85], v17 offset:8192
    v_mfma_f32_16x16x32_bf16 v[132:135], v[68:71], v[36:39], v[132:135]
    v_mfma_f32_16x16x32_bf16 v[136:139], v[72:75], v[36:39], v[136:139]
    ds_read_b64_tr_b16 v[86:87], v17 offset:10240
    v_mfma_f32_16x16x32_bf16 v[140:143], v[76:79], v[36:39], v[140:143]
    ds_read_b64_tr_b16 v[88:89], v18 offset:8192
    v_mfma_f32_16x16x32_bf16 v[144:147], v[80:83], v[36:39], v[144:147]
    v_mfma_f32_16x16x32_bf16 v[148:151], v[68:71], v[40:43], v[148:151]
    ds_read_b64_tr_b16 v[90:91], v18 offset:10240
    v_mfma_f32_16x16x32_bf16 v[152:155], v[72:75], v[40:43], v[152:155]
    ds_read_b64_tr_b16 v[92:93], v19 offset:8192
    v_mfma_f32_16x16x32_bf16 v[156:159], v[76:79], v[40:43], v[156:159]
    v_mfma_f32_16x16x32_bf16 v[160:163], v[80:83], v[40:43], v[160:163]
    ds_read_b64_tr_b16 v[94:95], v19 offset:10240
    v_mfma_f32_16x16x32_bf16 v[164:167], v[68:71], v[44:47], v[164:167]
    ds_read_b64_tr_b16 v[96:97], v20 offset:8192
    v_mfma_f32_16x16x32_bf16 v[168:171], v[72:75], v[44:47], v[168:171]
    v_mfma_f32_16x16x32_bf16 v[172:175], v[76:79], v[44:47], v[172:175]
    ds_read_b64_tr_b16 v[98:99], v20 offset:10240
    v_mfma_f32_16x16x32_bf16 v[176:179], v[80:83], v[44:47], v[176:179]
    s_waitcnt lgkmcnt(0)
    v_mfma_f32_16x16x32_bf16 v[100:103], v[84:87], v[48:51], v[100:103]
    ds_read_b128 v[28:31], v16 offset:0
    v_mfma_f32_16x16x32_bf16 v[104:107], v[88:91], v[48:51], v[104:107]
    ds_read_b128 v[32:35], v16 offset:2048
    v_mfma_f32_16x16x32_bf16 v[108:111], v[92:95], v[48:51], v[108:111]
    v_mfma_f32_16x16x32_bf16 v[112:115], v[96:99], v[48:51], v[112:115]
    ds_read_b128 v[36:39], v16 offset:4096
    v_mfma_f32_16x16x32_bf16 v[116:119], v[84:87], v[52:55], v[116:119]
    ds_read_b128 v[40:43], v16 offset:6144
    v_mfma_f32_16x16x32_bf16 v[120:123], v[88:91], v[52:55], v[120:123]
    v_mfma_f32_16x16x32_bf16 v[124:127], v[92:95], v[52:55], v[124:127]
    ds_read_b128 v[44:47], v16 offset:8192
    v_mfma_f32_16x16x32_bf16 v[128:131], v[96:99], v[52:55], v[128:131]
    ds_read_b64_tr_b16 v[68:69], v21 offset:0
    v_mfma_f32_16x16x32_bf16 v[132:135], v[84:87], v[56:59], v[132:135]
    v_mfma_f32_16x16x32_bf16 v[136:139], v[88:91], v[56:59], v[136:139]
    ds_read_b64_tr_b16 v[70:71], v21 offset:2048
    v_mfma_f32_16x16x32_bf16 v[140:143], v[92:95], v[56:59], v[140:143]
    ds_read_b64_tr_b16 v[72:73], v22 offset:0
    v_mfma_f32_16x16x32_bf16 v[144:147], v[96:99], v[56:59], v[144:147]
    v_mfma_f32_16x16x32_bf16 v[148:151], v[84:87], v[60:63], v[148:151]
    ds_read_b64_tr_b16 v[74:75], v22 offset:2048
    v_mfma_f32_16x16x32_bf16 v[152:155], v[88:91], v[60:63], v[152:155]
    ds_read_b64_tr_b16 v[76:77], v23 offset:0
    v_mfma_f32_16x16x32_bf16 v[156:159], v[92:95], v[60:63], v[156:159]
    v_mfma_f32_16x16x32_bf16 v[160:163], v[96:99], v[60:63], v[160:163]
    ds_read_b64_tr_b16 v[78:79], v23 offset:2048
    v_mfma_f32_16x16x32_bf16 v[164:167], v[84:87], v[64:67], v[164:167]
    ds_read_b64_tr_b16 v[80:81], v24 offset:0
    v_mfma_f32_16x16x32_bf16 v[168:171], v[88:91], v[64:67], v[168:171]
    v_mfma_f32_16x16x32_bf16 v[172:175], v[92:95], v[64:67], v[172:175]
    ds_read_b64_tr_b16 v[82:83], v24 offset:2048
    v_mfma_f32_16x16x32_bf16 v[176:179], v[96:99], v[64:67], v[176:179]
    s_mov_b32 s70, s71
    s_add_u32 s71, s71, 36864
    s_cmp_ge_u32 s71, 147456
    s_cselect_b32 s71, 0, s71
    s_add_u32 s74, s74, 1
    s_cmp_lt_u32 s74, 12
    s_cbranch_scc1 L_qkv_kernel_cl
L_qkv_kernel_cx:
    s_waitcnt lgkmcnt(0)
    s_nop 9
    v_cvt_pk_bf16_f32 v184, v100, v101
    v_cvt_pk_bf16_f32 v185, v102, v103
    v_cvt_pk_bf16_f32 v186, v104, v105
    v_cvt_pk_bf16_f32 v187, v106, v107
    s_nop 1
    v_permlane16_swap_b32 v184, v186
    v_permlane16_swap_b32 v185, v187
    buffer_store_dwordx4 v[184:187], v195, s[24:27], s49 offen offset:0
    v_cvt_pk_bf16_f32 v188, v108, v109
    v_cvt_pk_bf16_f32 v189, v110, v111
    v_cvt_pk_bf16_f32 v190, v112, v113
    v_cvt_pk_bf16_f32 v191, v114, v115
    s_nop 1
    v_permlane16_swap_b32 v188, v190
    v_permlane16_swap_b32 v189, v191
    buffer_store_dwordx4 v[188:191], v195, s[24:27], s49 offen offset:64
    v_cvt_pk_bf16_f32 v184, v116, v117
    v_cvt_pk_bf16_f32 v185, v118, v119
    v_cvt_pk_bf16_f32 v186, v120, v121
    v_cvt_pk_bf16_f32 v187, v122, v123
    s_nop 1
    v_permlane16_swap_b32 v184, v186
    v_permlane16_swap_b32 v185, v187
    buffer_store_dwordx4 v[184:187], v196, s[24:27], s49 offen offset:0
    v_cvt_pk_bf16_f32 v188, v124, v125
    v_cvt_pk_bf16_f32 v189, v126, v127
    v_cvt_pk_bf16_f32 v190, v128, v129
    v_cvt_pk_bf16_f32 v191, v130, v131
    s_nop 1
    v_permlane16_swap_b32 v188, v190
    v_permlane16_swap_b32 v189, v191
    buffer_store_dwordx4 v[188:191], v196, s[24:27], s49 offen offset:64
    v_cvt_pk_bf16_f32 v184, v132, v133
    v_cvt_pk_bf16_f32 v185, v134, v135
    v_cvt_pk_bf16_f32 v186, v136, v137
    v_cvt_pk_bf16_f32 v187, v138, v139
    s_nop 1
    v_permlane16_swap_b32 v184, v186
    v_permlane16_swap_b32 v185, v187
    buffer_store_dwordx4 v[184:187], v197, s[24:27], s49 offen offset:0
    v_cvt_pk_bf16_f32 v188, v140, v141
    v_cvt_pk_bf16_f32 v189, v142, v143
    v_cvt_pk_bf16_f32 v190, v144, v145
    v_cvt_pk_bf16_f32 v191, v146, v147
    s_nop 1
    v_permlane16_swap_b32 v188, v190
    v_permlane16_swap_b32 v189, v191
    buffer_store_dwordx4 v[188:191], v197, s[24:27], s49 offen offset:64
    v_cvt_pk_bf16_f32 v184, v148, v149
    v_cvt_pk_bf16_f32 v185, v150, v151
    v_cvt_pk_bf16_f32 v186, v152, v153
    v_cvt_pk_bf16_f32 v187, v154, v155
    s_nop 1
    v_permlane16_swap_b32 v184, v186
    v_permlane16_swap_b32 v185, v187
    buffer_store_dwordx4 v[184:187], v198, s[24:27], s49 offen offset:0
    v_cvt_pk_bf16_f32 v188, v156, v157
    v_cvt_pk_bf16_f32 v189, v158, v159
    v_cvt_pk_bf16_f32 v190, v160, v161
    v_cvt_pk_bf16_f32 v191, v162, v163
    s_nop 1
    v_permlane16_swap_b32 v188, v190
    v_permlane16_swap_b32 v189, v191
    buffer_store_dwordx4 v[188:191], v198, s[24:27], s49 offen offset:64
    v_cvt_pk_bf16_f32 v184, v164, v165
    v_cvt_pk_bf16_f32 v185, v166, v167
    v_cvt_pk_bf16_f32 v186, v168, v169
    v_cvt_pk_bf16_f32 v187, v170, v171
    s_nop 1
    v_permlane16_swap_b32 v184, v186
    v_permlane16_swap_b32 v185, v187
    buffer_store_dwordx4 v[184:187], v199, s[24:27], s49 offen offset:0
    v_cvt_pk_bf16_f32 v188, v172, v173
    v_cvt_pk_bf16_f32 v189, v174, v175
    v_cvt_pk_bf16_f32 v190, v176, v177
    v_cvt_pk_bf16_f32 v191, v178, v179
    s_nop 1
    v_permlane16_swap_b32 v188, v190
    v_permlane16_swap_b32 v189, v191
    buffer_store_dwordx4 v[188:191], v199, s[24:27], s49 offen offset:64
    s_endpgm
L_qkv_kernel_loader:
    s_sub_u32 s75, s36, 4
    s_lshl_b32 s75, s75, 10
    s_lshr_b32 s37, s75, 4
    v_add_u32 v3, s37, v1
    v_lshrrev_b32 v4, 3, v3
    v_xor_b32 v16, v4, v3
    v_and_b32 v16, 7, v16
    v_lshlrev_b32 v16, 4, v16
    v_add_u32 v4, s45, v4
    v_min_u32 v4, s46, v4
    v_lshlrev_b32 v4, 7, v4
    v_add_u32 v16, v16, v4
    v_add_u32 v3, s37, v1
    v_add_u32 v3, 256, v3
    v_lshrrev_b32 v4, 3, v3
    v_xor_b32 v17, v4, v3
    v_and_b32 v17, 7, v17
    v_lshlrev_b32 v17, 4, v17
    v_add_u32 v4, s45, v4
    v_min_u32 v4, s46, v4
    v_lshlrev_b32 v4, 7, v4
    v_add_u32 v17, v17, v4
    v_add_u32 v3, s37, v1
    v_add_u32 v3, 512, v3
    v_lshrrev_b32 v4, 3, v3
    v_xor_b32 v18, v4, v3
    v_and_b32 v18, 7, v18
    v_lshlrev_b32 v18, 4, v18
    v_add_u32 v4, s45, v4
    v_min_u32 v4, s46, v4
    v_lshlrev_b32 v4, 7, v4
    v_add_u32 v18, v18, v4
    v_add_u32 v3, s37, v1
    v_add_u32 v3, 768, v3
    v_lshrrev_b32 v4, 3, v3
    v_xor_b32 v19, v4, v3
    v_and_b32 v19, 7, v19
    v_lshlrev_b32 v19, 4, v19
    v_add_u32 v4, s45, v4
    v_min_u32 v4, s46, v4
    v_lshlrev_b32 v4, 7, v4
    v_add_u32 v19, v19, v4
    v_add_u32 v3, s37, v1
    v_add_u32 v3, 1024, v3
    v_lshrrev_b32 v4, 3, v3
    v_xor_b32 v20, v4, v3
    v_and_b32 v20, 7, v20
    v_lshlrev_b32 v20, 4, v20
    v_add_u32 v4, s45, v4
    v_min_u32 v4, s46, v4
    v_lshlrev_b32 v4, 7, v4
    v_add_u32 v20, v20, v4
    v_add_u32 v3, s37, v1
    v_lshrrev_b32 v5, 4, v3
    v_bfe_u32 v7, v3, 1, 3
    v_xor_b32 v7, v7, v5
    v_and_b32 v7, 7, v7
    v_lshlrev_b32 v7, 5, v7
    v_and_b32 v6, 1, v3
    v_lshl_add_u32 v21, v6, 4, v7
    v_and_b32 v4, 0xfffffff3, v5
    v_bfe_u32 v6, v5, 2, 1
    v_bfe_u32 v7, v5, 3, 1
    v_lshl_or_b32 v4, v6, 3, v4
    v_lshl_or_b32 v4, v7, 2, v4
    v_mul_u32_u24 v4, 4608, v4
    v_add_u32 v4, s47, v4
    v_add_u32 v21, v21, v4
    v_add_u32 v3, s37, v1
    v_add_u32 v3, 256, v3
    v_lshrrev_b32 v5, 4, v3
    v_bfe_u32 v7, v3, 1, 3
    v_xor_b32 v7, v7, v5
    v_and_b32 v7, 7, v7
    v_lshlrev_b32 v7, 5, v7
    v_and_b32 v6, 1, v3
    v_lshl_add_u32 v22, v6, 4, v7
    v_and_b32 v4, 0xfffffff3, v5
    v_bfe_u32 v6, v5, 2, 1
    v_bfe_u32 v7, v5, 3, 1
    v_lshl_or_b32 v4, v6, 3, v4
    v_lshl_or_b32 v4, v7, 2, v4
    v_mul_u32_u24 v4, 4608, v4
    v_add_u32 v4, s47, v4
    v_add_u32 v22, v22, v4
    v_add_u32 v3, s37, v1
    v_add_u32 v3, 512, v3
    v_lshrrev_b32 v5, 4, v3
    v_bfe_u32 v7, v3, 1, 3
    v_xor_b32 v7, v7, v5
    v_and_b32 v7, 7, v7
    v_lshlrev_b32 v7, 5, v7
    v_and_b32 v6, 1, v3
    v_lshl_add_u32 v23, v6, 4, v7
    v_and_b32 v4, 0xfffffff3, v5
    v_bfe_u32 v6, v5, 2, 1
    v_bfe_u32 v7, v5, 3, 1
    v_lshl_or_b32 v4, v6, 3, v4
    v_lshl_or_b32 v4, v7, 2, v4
    v_mul_u32_u24 v4, 4608, v4
    v_add_u32 v4, s47, v4
    v_add_u32 v23, v23, v4
    v_add_u32 v3, s37, v1
    v_add_u32 v3, 768, v3
    v_lshrrev_b32 v5, 4, v3
    v_bfe_u32 v7, v3, 1, 3
    v_xor_b32 v7, v7, v5
    v_and_b32 v7, 7, v7
    v_lshlrev_b32 v7, 5, v7
    v_and_b32 v6, 1, v3
    v_lshl_add_u32 v24, v6, 4, v7
    v_and_b32 v4, 0xfffffff3, v5
    v_bfe_u32 v6, v5, 2, 1
    v_bfe_u32 v7, v5, 3, 1
    v_lshl_or_b32 v4, v6, 3, v4
    v_lshl_or_b32 v4, v7, 2, v4
    v_mul_u32_u24 v4, 4608, v4
    v_add_u32 v4, s47, v4
    v_add_u32 v24, v24, v4
    s_waitcnt lgkmcnt(0)
    s_cmp_eq_u32 s43, 13
    s_cselect_b32 s10, s6, s4
    s_cselect_b32 s11, s7, s5
    s_add_u32 s12, s8, s48
    s_addc_u32 s13, s9, 0

    s_add_u32 s78, s43, s44
    s_mul_hi_u32 s79, s78, 715827883
    s_mul_i32 s79, s79, 6
    s_sub_u32 s78, s78, s79
    s_lshl_b32 s78, s78, 1

    s_mov_b32 s78, 0
    s_add_u32 s16, s8, 65536
    s_addc_u32 s17, s9, 0
    s_mov_b32 s18, 3244032
    s_mov_b32 s19, 0x00020000
    s_mov_b32 s20, s10
    s_mov_b32 s21, s11
    s_mov_b32 s22, 3538944
    s_mov_b32 s23, 0x00020000
    s_add_u32 s24, s12, 4259840
    s_addc_u32 s25, s13, 0
    s_mov_b32 s26, 3244032
    s_mov_b32 s27, 0x00020000
    s_mov_b32 s70, s75
    s_mul_i32 s72, s78, 270336
    s_mul_i32 s73, s78, 294912
    s_mov_b32 s74, 0
L_qkv_kernel_ld0:
    s_add_u32 m0, s70, 0
    s_nop 0
    buffer_load_dwordx4 v16, s[16:19], s72 offen lds
    s_add_u32 m0, s70, 4096
    s_nop 0
    buffer_load_dwordx4 v17, s[16:19], s72 offen lds
    s_add_u32 m0, s70, 8192
    s_nop 0
    buffer_load_dwordx4 v18, s[16:19], s72 offen lds
    s_add_u32 m0, s70, 12288
    s_nop 0
    buffer_load_dwordx4 v19, s[16:19], s72 offen lds
    s_add_u32 m0, s70, 16384
    s_nop 0
    buffer_load_dwordx4 v20, s[16:19], s72 offen lds
    s_add_u32 m0, s70, 20480
    s_nop 0
    buffer_load_dwordx4 v21, s[20:23], s73 offen lds
    s_add_u32 m0, s70, 24576
    s_nop 0
    buffer_load_dwordx4 v22, s[20:23], s73 offen lds
    s_add_u32 m0, s70, 28672
    s_nop 0
    buffer_load_dwordx4 v23, s[20:23], s73 offen lds
    s_add_u32 m0, s70, 32768
    s_nop 0
    buffer_load_dwordx4 v24, s[20:23], s73 offen lds
    s_add_u32 s72, s72, 270336
    s_add_u32 s73, s73, 294912
    s_cmp_ge_u32 s72, 3244032
    s_cselect_b32 s72, 0, s72
    s_cselect_b32 s73, 0, s73
    s_add_u32 s70, s70, 36864
    s_cmp_ge_u32 s70, 147456
    s_cselect_b32 s38, 147456, 0
    s_sub_u32 s70, s70, s38
    s_add_u32 s74, s74, 1
    s_cmp_lt_u32 s74, 3
    s_cbranch_scc1 L_qkv_kernel_ld0
    s_waitcnt vmcnt(18)
    s_barrier
L_qkv_kernel_ld:
    s_waitcnt vmcnt(9)
    s_barrier
    s_cmp_ge_u32 s74, 12
    s_cselect_b32 s18, 0, s18
    s_cselect_b32 s22, 0, s22
    s_add_u32 m0, s70, 0
    s_nop 0
    buffer_load_dwordx4 v16, s[16:19], s72 offen lds
    s_add_u32 m0, s70, 4096
    s_nop 0
    buffer_load_dwordx4 v17, s[16:19], s72 offen lds
    s_add_u32 m0, s70, 8192
    s_nop 0
    buffer_load_dwordx4 v18, s[16:19], s72 offen lds
    s_add_u32 m0, s70, 12288
    s_nop 0
    buffer_load_dwordx4 v19, s[16:19], s72 offen lds
    s_add_u32 m0, s70, 16384
    s_nop 0
    buffer_load_dwordx4 v20, s[16:19], s72 offen lds
    s_add_u32 m0, s70, 20480
    s_nop 0
    buffer_load_dwordx4 v21, s[20:23], s73 offen lds
    s_add_u32 m0, s70, 24576
    s_nop 0
    buffer_load_dwordx4 v22, s[20:23], s73 offen lds
    s_add_u32 m0, s70, 28672
    s_nop 0
    buffer_load_dwordx4 v23, s[20:23], s73 offen lds
    s_add_u32 m0, s70, 32768
    s_nop 0
    buffer_load_dwordx4 v24, s[20:23], s73 offen lds
    s_add_u32 s72, s72, 270336
    s_add_u32 s73, s73, 294912
    s_cmp_ge_u32 s72, 3244032
    s_cselect_b32 s72, 0, s72
    s_cselect_b32 s73, 0, s73
    s_add_u32 s70, s70, 36864
    s_cmp_ge_u32 s70, 147456
    s_cselect_b32 s38, 147456, 0
    s_sub_u32 s70, s70, s38
    s_add_u32 s74, s74, 1
    s_cmp_lt_u32 s74, 15
    s_cbranch_scc1 L_qkv_kernel_ld
    s_waitcnt vmcnt(0)
    s_endpgm
L_qkv_kernel_end:
    s_endpgm
.globl sv_kernel
.p2align 8
.type sv_kernel,@function
sv_kernel:
    s_cmp_ge_u32 s2, 232
    s_cbranch_scc1 L_sv_end
    s_load_dwordx2 s[8:9], s[0:1], 88
    s_load_dwordx2 s[12:13], s[0:1], 40
    s_and_b32 s40, s2, 7
    s_lshr_b32 s41, s2, 3
    s_mul_i32 s40, s40, 29
    s_add_u32 s40, s40, s41
    s_cmp_ge_u32 s40, 228
    s_cbranch_scc1 L_sv_end
    s_cmp_ge_u32 s40, 114
    s_cselect_b32 s41, 1, 0
    s_mul_i32 s42, s41, 114
    s_sub_u32 s42, s40, s42
    s_mul_i32 s45, s41, 1056

    v_lshrrev_b32 v2, 6, v0
    v_and_b32 v1, 63, v0
    s_nop 0
    v_readfirstlane_b32 s36, v2
    s_nop 3
    s_cmp_ge_u32 s42, 66
    s_cbranch_scc1 L_sv_vw
    s_mul_hi_u32 s43, s42, 390451573
    s_mul_i32 s44, s43, 11
    s_sub_u32 s44, s42, s44
    s_mul_i32 s55, s43, 176
    s_add_u32 s46, s55, s45
    s_mul_i32 s47, s44, 96
    s_add_u32 s47, s47, s45
    s_mul_i32 s49, s41, 11
    s_add_u32 s49, s49, s44
    s_mul_i32 s48, s49, 202752
    s_mul_i32 s49, s49, 4224
    s_mul_i32 s50, s43, 704
    s_add_u32 s49, s49, s50
    s_add_u32 s78, s43, s44
    s_mul_hi_u32 s79, s78, 357913942
    s_mul_i32 s79, s79, 12
    s_sub_u32 s78, s78, s79

    s_cmp_ge_u32 s36, 4
    s_cbranch_scc1 L_svs_loader
    v_lshrrev_b32 v2, 4, v1
    v_and_b32 v3, 15, v1
    s_lshr_b32 s76, s36, 1
    s_and_b32 s77, s36, 1
    s_mul_i32 s38, s76, 12288
    v_and_b32 v4, 7, v1
    v_xor_b32 v4, v4, v2
    v_lshlrev_b32 v4, 4, v4
    v_lshl_add_u32 v8, v3, 7, v4
    v_add_u32 v8, s38, v8
    v_and_b32 v4, 7, v1
    v_xor_b32 v4, v4, v2
    v_xor_b32 v4, 4, v4
    v_lshlrev_b32 v4, 4, v4
    v_lshl_add_u32 v9, v3, 7, v4
    v_add_u32 v9, s38, v9
    s_mul_i32 s38, s77, 6144
    s_add_u32 s38, s38, 24576
    v_and_b32 v4, 7, v1
    v_xor_b32 v4, v4, v2
    v_lshlrev_b32 v4, 4, v4
    v_lshl_add_u32 v10, v3, 7, v4
    v_add_u32 v10, s38, v10
    v_and_b32 v4, 7, v1
    v_xor_b32 v4, v4, v2
    v_xor_b32 v4, 4, v4
    v_lshlrev_b32 v4, 4, v4
    v_lshl_add_u32 v11, v3, 7, v4
    v_add_u32 v11, s38, v11
    v_mov_b32 v92, 0
    v_mov_b32 v93, 0
    v_mov_b32 v94, 0
    v_mov_b32 v95, 0
    v_mov_b32 v96, 0
    v_mov_b32 v97, 0
    v_mov_b32 v98, 0
    v_mov_b32 v99, 0
    v_mov_b32 v100, 0
    v_mov_b32 v101, 0
    v_mov_b32 v102, 0
    v_mov_b32 v103, 0
    v_mov_b32 v104, 0
    v_mov_b32 v105, 0
    v_mov_b32 v106, 0
    v_mov_b32 v107, 0
    v_mov_b32 v108, 0
    v_mov_b32 v109, 0
    v_mov_b32 v110, 0
    v_mov_b32 v111, 0
    v_mov_b32 v112, 0
    v_mov_b32 v113, 0
    v_mov_b32 v114, 0
    v_mov_b32 v115, 0
    v_mov_b32 v116, 0
    v_mov_b32 v117, 0
    v_mov_b32 v118, 0
    v_mov_b32 v119, 0
    v_mov_b32 v120, 0
    v_mov_b32 v121, 0
    v_mov_b32 v122, 0
    v_mov_b32 v123, 0
    v_mov_b32 v124, 0
    v_mov_b32 v125, 0
    v_mov_b32 v126, 0
    v_mov_b32 v127, 0
    v_mov_b32 v128, 0
    v_mov_b32 v129, 0
    v_mov_b32 v130, 0
    v_mov_b32 v131, 0
    v_mov_b32 v132, 0
    v_mov_b32 v133, 0
    v_mov_b32 v134, 0
    v_mov_b32 v135, 0
    v_mov_b32 v136, 0
    v_mov_b32 v137, 0
    v_mov_b32 v138, 0
    v_mov_b32 v139, 0
    v_mov_b32 v140, 0
    v_mov_b32 v141, 0
    v_mov_b32 v142, 0
    v_mov_b32 v143, 0
    v_mov_b32 v144, 0
    v_mov_b32 v145, 0
    v_mov_b32 v146, 0
    v_mov_b32 v147, 0
    v_mov_b32 v148, 0
    v_mov_b32 v149, 0
    v_mov_b32 v150, 0
    v_mov_b32 v151, 0
    v_mov_b32 v152, 0
    v_mov_b32 v153, 0
    v_mov_b32 v154, 0
    v_mov_b32 v155, 0
    v_mov_b32 v156, 0
    v_mov_b32 v157, 0
    v_mov_b32 v158, 0
    v_mov_b32 v159, 0
    v_mov_b32 v160, 0
    v_mov_b32 v161, 0
    v_mov_b32 v162, 0
    v_mov_b32 v163, 0
    s_waitcnt lgkmcnt(0)
    s_add_u32 s16, s8, 4259840
    s_addc_u32 s17, s9, 0
    s_mov_b32 s18, 3244032
    s_mov_b32 s19, 0x00020000
    s_add_u32 s20, s8, 8454144
    s_addc_u32 s21, s9, 0
    s_mov_b32 s22, 3244032
    s_mov_b32 s23, 0x00020000
    s_add_u32 s24, s8, 16842752
    s_addc_u32 s25, s9, 0
    s_mov_b32 s26, 4460544
    s_mov_b32 s27, 0x00020000
    s_add_u32 s28, s8, 25231360
    s_addc_u32 s29, s9, 0
    s_mov_b32 s30, 185856
    s_mov_b32 s31, 0x00020000
    s_mul_i32 s38, s77, 96
    v_and_b32 v164, 1, v2
    v_lshlrev_b32 v164, 5, v164
    v_lshrrev_b32 v166, 1, v2
    v_lshl_add_u32 v164, v166, 4, v164
    v_add_u32 v164, s38, v164
    v_lshlrev_b32 v165, 3, v2
    v_add_u32 v165, s38, v165
    s_mul_i32 s39, s76, 96
    s_add_u32 s51, s39, s55
    v_add_u32 v192, s51, v3
    v_mul_u32_u24 v192, 192, v192
    v_add_u32 v176, v192, v164
    v_add_u32 v182, v192, v165
    v_add_u32 v192, s51, v3
    v_add_u32 v192, 16, v192
    v_mul_u32_u24 v192, 192, v192
    v_add_u32 v177, v192, v164
    v_add_u32 v183, v192, v165
    v_add_u32 v192, s51, v3
    v_add_u32 v192, 32, v192
    v_mul_u32_u24 v192, 192, v192
    v_add_u32 v178, v192, v164
    v_add_u32 v184, v192, v165
    v_add_u32 v192, s51, v3
    v_add_u32 v192, 48, v192
    v_mul_u32_u24 v192, 192, v192
    v_add_u32 v179, v192, v164
    v_add_u32 v185, v192, v165
    v_add_u32 v192, s51, v3
    v_add_u32 v192, 64, v192
    v_mul_u32_u24 v192, 192, v192
    v_add_u32 v180, v192, v164
    v_add_u32 v186, v192, v165
    v_add_u32 v192, s51, v3
    v_add_u32 v192, 80, v192
    v_mul_u32_u24 v192, 192, v192
    s_cmp_eq_u32 s76, 1
    s_cselect_b32 s38, 0x7ffffff, 0
    v_add_u32 v192, s38, v192
    v_add_u32 v181, v192, v164
    v_add_u32 v187, v192, v165
    v_add_u32 v192, s39, v3
    v_lshlrev_b32 v190, 2, v192
    v_mov_b32 v191, v190
    s_cmp_eq_u32 s76, 1
    s_cselect_b32 s38, 0x7ffffff, 0
    v_add_u32 v191, s38, v191
    v_lshlrev_b32 v189, 5, v192
    v_lshl_add_u32 v188, v2, 2, v189
    s_lshl_b32 s39, s77, 4
    v_add_u32 v188, s39, v188
    s_mov_b32 s51, 0x3d553b95
    s_mov_b32 s70, 0
    s_mov_b32 s71, 0
    v_add_u32 v12, s70, v8
    v_add_u32 v13, s70, v9
    v_add_u32 v14, s71, v8
    v_add_u32 v15, s70, v10
    v_add_u32 v16, s70, v11
    v_add_u32 v17, s71, v10
    s_barrier
    ds_read_b128 v[20:23], v14 offset:0
    ds_read_b128 v[24:27], v14 offset:2048
    ds_read_b128 v[28:31], v14 offset:4096
    ds_read_b128 v[32:35], v14 offset:6144
    ds_read_b128 v[36:39], v14 offset:8192
    ds_read_b128 v[40:43], v14 offset:10240
    ds_read_b128 v[68:71], v17 offset:0
    ds_read_b128 v[72:75], v17 offset:2048
    ds_read_b128 v[76:79], v17 offset:4096
    s_mov_b32 s71, 36864
    s_mov_b32 s74, 0
L_svs_cl:
    s_barrier
    v_add_u32 v12, s70, v8
    v_add_u32 v13, s70, v9
    v_add_u32 v14, s71, v8
    v_add_u32 v15, s70, v10
    v_add_u32 v16, s70, v11
    v_add_u32 v17, s71, v10
    s_waitcnt lgkmcnt(0)
    v_mfma_f32_16x16x32_bf16 v[92:95], v[68:71], v[20:23], v[92:95]
    ds_read_b128 v[44:47], v13 offset:0
    v_mfma_f32_16x16x32_bf16 v[96:99], v[72:75], v[20:23], v[96:99]
    v_mfma_f32_16x16x32_bf16 v[100:103], v[76:79], v[20:23], v[100:103]
    ds_read_b128 v[48:51], v13 offset:2048
    v_mfma_f32_16x16x32_bf16 v[104:107], v[68:71], v[24:27], v[104:107]
    v_mfma_f32_16x16x32_bf16 v[108:111], v[72:75], v[24:27], v[108:111]
    ds_read_b128 v[52:55], v13 offset:4096
    v_mfma_f32_16x16x32_bf16 v[112:115], v[76:79], v[24:27], v[112:115]
    v_mfma_f32_16x16x32_bf16 v[116:119], v[68:71], v[28:31], v[116:119]
    ds_read_b128 v[56:59], v13 offset:6144
    v_mfma_f32_16x16x32_bf16 v[120:123], v[72:75], v[28:31], v[120:123]
    v_mfma_f32_16x16x32_bf16 v[124:127], v[76:79], v[28:31], v[124:127]
    ds_read_b128 v[60:63], v13 offset:8192
    v_mfma_f32_16x16x32_bf16 v[128:131], v[68:71], v[32:35], v[128:131]
    v_mfma_f32_16x16x32_bf16 v[132:135], v[72:75], v[32:35], v[132:135]
    ds_read_b128 v[64:67], v13 offset:10240
    v_mfma_f32_16x16x32_bf16 v[136:139], v[76:79], v[32:35], v[136:139]
    v_mfma_f32_16x16x32_bf16 v[140:143], v[68:71], v[36:39], v[140:143]
    ds_read_b128 v[80:83], v16 offset:0
    v_mfma_f32_16x16x32_bf16 v[144:147], v[72:75], v[36:39], v[144:147]
    v_mfma_f32_16x16x32_bf16 v[148:151], v[76:79], v[36:39], v[148:151]
    ds_read_b128 v[84:87], v16 offset:2048
    v_mfma_f32_16x16x32_bf16 v[152:155], v[68:71], v[40:43], v[152:155]
    v_mfma_f32_16x16x32_bf16 v[156:159], v[72:75], v[40:43], v[156:159]
    ds_read_b128 v[88:91], v16 offset:4096
    v_mfma_f32_16x16x32_bf16 v[160:163], v[76:79], v[40:43], v[160:163]
    s_waitcnt lgkmcnt(0)
    v_mfma_f32_16x16x32_bf16 v[92:95], v[80:83], v[44:47], v[92:95]
    ds_read_b128 v[20:23], v14 offset:0
    v_mfma_f32_16x16x32_bf16 v[96:99], v[84:87], v[44:47], v[96:99]
    v_mfma_f32_16x16x32_bf16 v[100:103], v[88:91], v[44:47], v[100:103]
    ds_read_b128 v[24:27], v14 offset:2048
    v_mfma_f32_16x16x32_bf16 v[104:107], v[80:83], v[48:51], v[104:107]
    v_mfma_f32_16x16x32_bf16 v[108:111], v[84:87], v[48:51], v[108:111]
    ds_read_b128 v[28:31], v14 offset:4096
    v_mfma_f32_16x16x32_bf16 v[112:115], v[88:91], v[48:51], v[112:115]
    v_mfma_f32_16x16x32_bf16 v[116:119], v[80:83], v[52:55], v[116:119]
    ds_read_b128 v[32:35], v14 offset:6144
    v_mfma_f32_16x16x32_bf16 v[120:123], v[84:87], v[52:55], v[120:123]
    v_mfma_f32_16x16x32_bf16 v[124:127], v[88:91], v[52:55], v[124:127]
    ds_read_b128 v[36:39], v14 offset:8192
    v_mfma_f32_16x16x32_bf16 v[128:131], v[80:83], v[56:59], v[128:131]
    v_mfma_f32_16x16x32_bf16 v[132:135], v[84:87], v[56:59], v[132:135]
    ds_read_b128 v[40:43], v14 offset:10240
    v_mfma_f32_16x16x32_bf16 v[136:139], v[88:91], v[56:59], v[136:139]
    v_mfma_f32_16x16x32_bf16 v[140:143], v[80:83], v[60:63], v[140:143]
    ds_read_b128 v[68:71], v17 offset:0
    v_mfma_f32_16x16x32_bf16 v[144:147], v[84:87], v[60:63], v[144:147]
    v_mfma_f32_16x16x32_bf16 v[148:151], v[88:91], v[60:63], v[148:151]
    ds_read_b128 v[72:75], v17 offset:2048
    v_mfma_f32_16x16x32_bf16 v[152:155], v[80:83], v[64:67], v[152:155]
    v_mfma_f32_16x16x32_bf16 v[156:159], v[84:87], v[64:67], v[156:159]
    ds_read_b128 v[76:79], v17 offset:4096
    v_mfma_f32_16x16x32_bf16 v[160:163], v[88:91], v[64:67], v[160:163]
    s_mov_b32 s70, s71
    s_add_u32 s71, s71, 36864
    s_cmp_ge_u32 s71, 147456
    s_cselect_b32 s71, 0, s71
    s_add_u32 s74, s74, 1
    s_cmp_lt_u32 s74, 12
    s_cbranch_scc1 L_svs_cl
L_svs_cx:
    s_waitcnt lgkmcnt(0)
    s_nop 9
    v_max3_f32 v193, v92, v93, v94
    v_max3_f32 v193, v193, v95, v96
    v_max3_f32 v193, v193, v97, v98
    v_max3_f32 v193, v193, v99, v100
    v_max3_f32 v193, v193, v101, v102
    v_max_f32 v193, v193, v103
    ds_write_b32 v188, v193 offset:0
    v_max3_f32 v194, v104, v105, v106
    v_max3_f32 v194, v194, v107, v108
    v_max3_f32 v194, v194, v109, v110
    v_max3_f32 v194, v194, v111, v112
    v_max3_f32 v194, v194, v113, v114
    v_max_f32 v194, v194, v115
    ds_write_b32 v188, v194 offset:512
    v_max3_f32 v195, v116, v117, v118
    v_max3_f32 v195, v195, v119, v120
    v_max3_f32 v195, v195, v121, v122
    v_max3_f32 v195, v195, v123, v124
    v_max3_f32 v195, v195, v125, v126
    v_max_f32 v195, v195, v127
    ds_write_b32 v188, v195 offset:1024
    v_max3_f32 v196, v128, v129, v130
    v_max3_f32 v196, v196, v131, v132
    v_max3_f32 v196, v196, v133, v134
    v_max3_f32 v196, v196, v135, v136
    v_max3_f32 v196, v196, v137, v138
    v_max_f32 v196, v196, v139
    ds_write_b32 v188, v196 offset:1536
    v_max3_f32 v197, v140, v141, v142
    v_max3_f32 v197, v197, v143, v144
    v_max3_f32 v197, v197, v145, v146
    v_max3_f32 v197, v197, v147, v148
    v_max3_f32 v197, v197, v149, v150
    v_max_f32 v197, v197, v151
    ds_write_b32 v188, v197 offset:2048
    v_max3_f32 v198, v152, v153, v154
    v_max3_f32 v198, v198, v155, v156
    v_max3_f32 v198, v198, v157, v158
    v_max3_f32 v198, v198, v159, v160
    v_max3_f32 v198, v198, v161, v162
    v_max_f32 v198, v198, v163
    ds_write_b32 v188, v198 offset:2560
    s_waitcnt lgkmcnt(0)
    s_barrier
    ds_read_b128 v[200:203], v189 offset:0
    ds_read_b128 v[204:207], v189 offset:16
    ds_read_b128 v[208:211], v189 offset:512
    ds_read_b128 v[212:215], v189 offset:528
    ds_read_b128 v[216:219], v189 offset:1024
    ds_read_b128 v[220:223], v189 offset:1040
    ds_read_b128 v[224:227], v189 offset:1536
    ds_read_b128 v[228:231], v189 offset:1552
    ds_read_b128 v[232:235], v189 offset:2048
    ds_read_b128 v[236:239], v189 offset:2064
    ds_read_b128 v[240:243], v189 offset:2560
    ds_read_b128 v[244:247], v189 offset:2576
    s_waitcnt lgkmcnt(0)
    v_max3_f32 v200, v200, v201, v202
    v_max3_f32 v200, v200, v203, v204
    v_max3_f32 v200, v200, v205, v206
    v_max_f32 v200, v200, v207
    v_mul_f32 v193, s51, v200
    v_max3_f32 v208, v208, v209, v210
    v_max3_f32 v208, v208, v211, v212
    v_max3_f32 v208, v208, v213, v214
    v_max_f32 v208, v208, v215
    v_mul_f32 v194, s51, v208
    v_max3_f32 v216, v216, v217, v218
    v_max3_f32 v216, v216, v219, v220
    v_max3_f32 v216, v216, v221, v222
    v_max_f32 v216, v216, v223
    v_mul_f32 v195, s51, v216
    v_max3_f32 v224, v224, v225, v226
    v_max3_f32 v224, v224, v227, v228
    v_max3_f32 v224, v224, v229, v230
    v_max_f32 v224, v224, v231
    v_mul_f32 v196, s51, v224
    v_max3_f32 v232, v232, v233, v234
    v_max3_f32 v232, v232, v235, v236
    v_max3_f32 v232, v232, v237, v238
    v_max_f32 v232, v232, v239
    v_mul_f32 v197, s51, v232
    v_max3_f32 v240, v240, v241, v242
    v_max3_f32 v240, v240, v243, v244
    v_max3_f32 v240, v240, v245, v246
    v_max_f32 v240, v240, v247
    v_mul_f32 v198, s51, v240
    v_fma_f32 v92, v92, s51, -v193
    v_fma_f32 v93, v93, s51, -v193
    v_fma_f32 v94, v94, s51, -v193
    v_fma_f32 v95, v95, s51, -v193
    v_fma_f32 v96, v96, s51, -v193
    v_fma_f32 v97, v97, s51, -v193
    v_fma_f32 v98, v98, s51, -v193
    v_fma_f32 v99, v99, s51, -v193
    v_fma_f32 v100, v100, s51, -v193
    v_fma_f32 v101, v101, s51, -v193
    v_fma_f32 v102, v102, s51, -v193
    v_fma_f32 v103, v103, s51, -v193
    v_exp_f32 v92, v92
    v_exp_f32 v93, v93
    v_exp_f32 v94, v94
    v_exp_f32 v95, v95
    v_exp_f32 v96, v96
    v_exp_f32 v97, v97
    v_exp_f32 v98, v98
    v_exp_f32 v99, v99
    v_exp_f32 v100, v100
    v_exp_f32 v101, v101
    v_exp_f32 v102, v102
    v_exp_f32 v103, v103
    s_nop 0
    v_add_f32 v199, v92, v93
    v_add_f32 v199, v199, v94
    v_add_f32 v199, v199, v95
    v_add_f32 v199, v199, v96
    v_add_f32 v199, v199, v97
    v_add_f32 v199, v199, v98
    v_add_f32 v199, v199, v99
    v_add_f32 v199, v199, v100
    v_add_f32 v199, v199, v101
    v_add_f32 v199, v199, v102
    v_add_f32 v199, v199, v103
    ds_write_b32 v188, v199 offset:8192
    v_cvt_pk_bf16_f32 v168, v92, v93
    v_cvt_pk_bf16_f32 v169, v94, v95
    v_cvt_pk_bf16_f32 v170, v96, v97
    v_cvt_pk_bf16_f32 v171, v98, v99
    s_nop 1
    v_permlane16_swap_b32 v168, v170
    v_permlane16_swap_b32 v169, v171
    buffer_store_dwordx4 v[168:171], v176, s[24:27], s48 offen offset:0
    v_cvt_pk_bf16_f32 v172, v100, v101
    v_cvt_pk_bf16_f32 v173, v102, v103
    buffer_store_dwordx2 v[172:173], v182, s[24:27], s48 offen offset:64
    v_fma_f32 v104, v104, s51, -v194
    v_fma_f32 v105, v105, s51, -v194
    v_fma_f32 v106, v106, s51, -v194
    v_fma_f32 v107, v107, s51, -v194
    v_fma_f32 v108, v108, s51, -v194
    v_fma_f32 v109, v109, s51, -v194
    v_fma_f32 v110, v110, s51, -v194
    v_fma_f32 v111, v111, s51, -v194
    v_fma_f32 v112, v112, s51, -v194
    v_fma_f32 v113, v113, s51, -v194
    v_fma_f32 v114, v114, s51, -v194
    v_fma_f32 v115, v115, s51, -v194
    v_exp_f32 v104, v104
    v_exp_f32 v105, v105
    v_exp_f32 v106, v106
    v_exp_f32 v107, v107
    v_exp_f32 v108, v108
    v_exp_f32 v109, v109
    v_exp_f32 v110, v110
    v_exp_f32 v111, v111
    v_exp_f32 v112, v112
    v_exp_f32 v113, v113
    v_exp_f32 v114, v114
    v_exp_f32 v115, v115
    s_nop 0
    v_add_f32 v199, v104, v105
    v_add_f32 v199, v199, v106
    v_add_f32 v199, v199, v107
    v_add_f32 v199, v199, v108
    v_add_f32 v199, v199, v109
    v_add_f32 v199, v199, v110
    v_add_f32 v199, v199, v111
    v_add_f32 v199, v199, v112
    v_add_f32 v199, v199, v113
    v_add_f32 v199, v199, v114
    v_add_f32 v199, v199, v115
    ds_write_b32 v188, v199 offset:8704
    v_cvt_pk_bf16_f32 v168, v104, v105
    v_cvt_pk_bf16_f32 v169, v106, v107
    v_cvt_pk_bf16_f32 v170, v108, v109
    v_cvt_pk_bf16_f32 v171, v110, v111
    s_nop 1
    v_permlane16_swap_b32 v168, v170
    v_permlane16_swap_b32 v169, v171
    buffer_store_dwordx4 v[168:171], v177, s[24:27], s48 offen offset:0
    v_cvt_pk_bf16_f32 v172, v112, v113
    v_cvt_pk_bf16_f32 v173, v114, v115
    buffer_store_dwordx2 v[172:173], v183, s[24:27], s48 offen offset:64
    v_fma_f32 v116, v116, s51, -v195
    v_fma_f32 v117, v117, s51, -v195
    v_fma_f32 v118, v118, s51, -v195
    v_fma_f32 v119, v119, s51, -v195
    v_fma_f32 v120, v120, s51, -v195
    v_fma_f32 v121, v121, s51, -v195
    v_fma_f32 v122, v122, s51, -v195
    v_fma_f32 v123, v123, s51, -v195
    v_fma_f32 v124, v124, s51, -v195
    v_fma_f32 v125, v125, s51, -v195
    v_fma_f32 v126, v126, s51, -v195
    v_fma_f32 v127, v127, s51, -v195
    v_exp_f32 v116, v116
    v_exp_f32 v117, v117
    v_exp_f32 v118, v118
    v_exp_f32 v119, v119
    v_exp_f32 v120, v120
    v_exp_f32 v121, v121
    v_exp_f32 v122, v122
    v_exp_f32 v123, v123
    v_exp_f32 v124, v124
    v_exp_f32 v125, v125
    v_exp_f32 v126, v126
    v_exp_f32 v127, v127
    s_nop 0
    v_add_f32 v199, v116, v117
    v_add_f32 v199, v199, v118
    v_add_f32 v199, v199, v119
    v_add_f32 v199, v199, v120
    v_add_f32 v199, v199, v121
    v_add_f32 v199, v199, v122
    v_add_f32 v199, v199, v123
    v_add_f32 v199, v199, v124
    v_add_f32 v199, v199, v125
    v_add_f32 v199, v199, v126
    v_add_f32 v199, v199, v127
    ds_write_b32 v188, v199 offset:9216
    v_cvt_pk_bf16_f32 v168, v116, v117
    v_cvt_pk_bf16_f32 v169, v118, v119
    v_cvt_pk_bf16_f32 v170, v120, v121
    v_cvt_pk_bf16_f32 v171, v122, v123
    s_nop 1
    v_permlane16_swap_b32 v168, v170
    v_permlane16_swap_b32 v169, v171
    buffer_store_dwordx4 v[168:171], v178, s[24:27], s48 offen offset:0
    v_cvt_pk_bf16_f32 v172, v124, v125
    v_cvt_pk_bf16_f32 v173, v126, v127
    buffer_store_dwordx2 v[172:173], v184, s[24:27], s48 offen offset:64
    v_fma_f32 v128, v128, s51, -v196
    v_fma_f32 v129, v129, s51, -v196
    v_fma_f32 v130, v130, s51, -v196
    v_fma_f32 v131, v131, s51, -v196
    v_fma_f32 v132, v132, s51, -v196
    v_fma_f32 v133, v133, s51, -v196
    v_fma_f32 v134, v134, s51, -v196
    v_fma_f32 v135, v135, s51, -v196
    v_fma_f32 v136, v136, s51, -v196
    v_fma_f32 v137, v137, s51, -v196
    v_fma_f32 v138, v138, s51, -v196
    v_fma_f32 v139, v139, s51, -v196
    v_exp_f32 v128, v128
    v_exp_f32 v129, v129
    v_exp_f32 v130, v130
    v_exp_f32 v131, v131
    v_exp_f32 v132, v132
    v_exp_f32 v133, v133
    v_exp_f32 v134, v134
    v_exp_f32 v135, v135
    v_exp_f32 v136, v136
    v_exp_f32 v137, v137
    v_exp_f32 v138, v138
    v_exp_f32 v139, v139
    s_nop 0
    v_add_f32 v199, v128, v129
    v_add_f32 v199, v199, v130
    v_add_f32 v199, v199, v131
    v_add_f32 v199, v199, v132
    v_add_f32 v199, v199, v133
    v_add_f32 v199, v199, v134
    v_add_f32 v199, v199, v135
    v_add_f32 v199, v199, v136
    v_add_f32 v199, v199, v137
    v_add_f32 v199, v199, v138
    v_add_f32 v199, v199, v139
    ds_write_b32 v188, v199 offset:9728
    v_cvt_pk_bf16_f32 v168, v128, v129
    v_cvt_pk_bf16_f32 v169, v130, v131
    v_cvt_pk_bf16_f32 v170, v132, v133
    v_cvt_pk_bf16_f32 v171, v134, v135
    s_nop 1
    v_permlane16_swap_b32 v168, v170
    v_permlane16_swap_b32 v169, v171
    buffer_store_dwordx4 v[168:171], v179, s[24:27], s48 offen offset:0
    v_cvt_pk_bf16_f32 v172, v136, v137
    v_cvt_pk_bf16_f32 v173, v138, v139
    buffer_store_dwordx2 v[172:173], v185, s[24:27], s48 offen offset:64
    v_fma_f32 v140, v140, s51, -v197
    v_fma_f32 v141, v141, s51, -v197
    v_fma_f32 v142, v142, s51, -v197
    v_fma_f32 v143, v143, s51, -v197
    v_fma_f32 v144, v144, s51, -v197
    v_fma_f32 v145, v145, s51, -v197
    v_fma_f32 v146, v146, s51, -v197
    v_fma_f32 v147, v147, s51, -v197
    v_fma_f32 v148, v148, s51, -v197
    v_fma_f32 v149, v149, s51, -v197
    v_fma_f32 v150, v150, s51, -v197
    v_fma_f32 v151, v151, s51, -v197
    v_exp_f32 v140, v140
    v_exp_f32 v141, v141
    v_exp_f32 v142, v142
    v_exp_f32 v143, v143
    v_exp_f32 v144, v144
    v_exp_f32 v145, v145
    v_exp_f32 v146, v146
    v_exp_f32 v147, v147
    v_exp_f32 v148, v148
    v_exp_f32 v149, v149
    v_exp_f32 v150, v150
    v_exp_f32 v151, v151
    s_nop 0
    v_add_f32 v199, v140, v141
    v_add_f32 v199, v199, v142
    v_add_f32 v199, v199, v143
    v_add_f32 v199, v199, v144
    v_add_f32 v199, v199, v145
    v_add_f32 v199, v199, v146
    v_add_f32 v199, v199, v147
    v_add_f32 v199, v199, v148
    v_add_f32 v199, v199, v149
    v_add_f32 v199, v199, v150
    v_add_f32 v199, v199, v151
    ds_write_b32 v188, v199 offset:10240
    v_cvt_pk_bf16_f32 v168, v140, v141
    v_cvt_pk_bf16_f32 v169, v142, v143
    v_cvt_pk_bf16_f32 v170, v144, v145
    v_cvt_pk_bf16_f32 v171, v146, v147
    s_nop 1
    v_permlane16_swap_b32 v168, v170
    v_permlane16_swap_b32 v169, v171
    buffer_store_dwordx4 v[168:171], v180, s[24:27], s48 offen offset:0
    v_cvt_pk_bf16_f32 v172, v148, v149
    v_cvt_pk_bf16_f32 v173, v150, v151
    buffer_store_dwordx2 v[172:173], v186, s[24:27], s48 offen offset:64
    v_fma_f32 v152, v152, s51, -v198
    v_fma_f32 v153, v153, s51, -v198
    v_fma_f32 v154, v154, s51, -v198
    v_fma_f32 v155, v155, s51, -v198
    v_fma_f32 v156, v156, s51, -v198
    v_fma_f32 v157, v157, s51, -v198
    v_fma_f32 v158, v158, s51, -v198
    v_fma_f32 v159, v159, s51, -v198
    v_fma_f32 v160, v160, s51, -v198
    v_fma_f32 v161, v161, s51, -v198
    v_fma_f32 v162, v162, s51, -v198
    v_fma_f32 v163, v163, s51, -v198
    v_exp_f32 v152, v152
    v_exp_f32 v153, v153
    v_exp_f32 v154, v154
    v_exp_f32 v155, v155
    v_exp_f32 v156, v156
    v_exp_f32 v157, v157
    v_exp_f32 v158, v158
    v_exp_f32 v159, v159
    v_exp_f32 v160, v160
    v_exp_f32 v161, v161
    v_exp_f32 v162, v162
    v_exp_f32 v163, v163
    s_nop 0
    v_add_f32 v199, v152, v153
    v_add_f32 v199, v199, v154
    v_add_f32 v199, v199, v155
    v_add_f32 v199, v199, v156
    v_add_f32 v199, v199, v157
    v_add_f32 v199, v199, v158
    v_add_f32 v199, v199, v159
    v_add_f32 v199, v199, v160
    v_add_f32 v199, v199, v161
    v_add_f32 v199, v199, v162
    v_add_f32 v199, v199, v163
    ds_write_b32 v188, v199 offset:10752
    v_cvt_pk_bf16_f32 v168, v152, v153
    v_cvt_pk_bf16_f32 v169, v154, v155
    v_cvt_pk_bf16_f32 v170, v156, v157
    v_cvt_pk_bf16_f32 v171, v158, v159
    s_nop 1
    v_permlane16_swap_b32 v168, v170
    v_permlane16_swap_b32 v169, v171
    buffer_store_dwordx4 v[168:171], v181, s[24:27], s48 offen offset:0
    v_cvt_pk_bf16_f32 v172, v160, v161
    v_cvt_pk_bf16_f32 v173, v162, v163
    buffer_store_dwordx2 v[172:173], v187, s[24:27], s48 offen offset:64
    s_waitcnt lgkmcnt(0)
    s_barrier
    s_cmp_eq_u32 s77, 0
    s_cbranch_scc0 L_svs_nostat
    v_cmp_eq_u32 vcc, 0, v2
    s_and_saveexec_b64 s[52:53], vcc
    ds_read_b128 v[200:203], v189 offset:8192
    ds_read_b128 v[204:207], v189 offset:8208
    ds_read_b128 v[208:211], v189 offset:8704
    ds_read_b128 v[212:215], v189 offset:8720
    ds_read_b128 v[216:219], v189 offset:9216
    ds_read_b128 v[220:223], v189 offset:9232
    ds_read_b128 v[224:227], v189 offset:9728
    ds_read_b128 v[228:231], v189 offset:9744
    ds_read_b128 v[232:235], v189 offset:10240
    ds_read_b128 v[236:239], v189 offset:10256
    ds_read_b128 v[240:243], v189 offset:10752
    ds_read_b128 v[244:247], v189 offset:10768
    s_waitcnt lgkmcnt(0)
    v_add_f32 v200, v200, v201
    v_add_f32 v202, v202, v203
    v_add_f32 v204, v204, v205
    v_add_f32 v206, v206, v207
    v_add_f32 v200, v200, v202
    v_add_f32 v204, v204, v206
    v_add_f32 v200, v200, v204
    v_add_u32 v199, 92928, v190
    buffer_store_dword v193, v190, s[28:31], s49 offen offset:0
    buffer_store_dword v200, v199, s[28:31], s49 offen offset:0
    v_add_f32 v208, v208, v209
    v_add_f32 v210, v210, v211
    v_add_f32 v212, v212, v213
    v_add_f32 v214, v214, v215
    v_add_f32 v208, v208, v210
    v_add_f32 v212, v212, v214
    v_add_f32 v208, v208, v212
    v_add_u32 v199, 92928, v190
    buffer_store_dword v194, v190, s[28:31], s49 offen offset:64
    buffer_store_dword v208, v199, s[28:31], s49 offen offset:64
    v_add_f32 v216, v216, v217
    v_add_f32 v218, v218, v219
    v_add_f32 v220, v220, v221
    v_add_f32 v222, v222, v223
    v_add_f32 v216, v216, v218
    v_add_f32 v220, v220, v222
    v_add_f32 v216, v216, v220
    v_add_u32 v199, 92928, v190
    buffer_store_dword v195, v190, s[28:31], s49 offen offset:128
    buffer_store_dword v216, v199, s[28:31], s49 offen offset:128
    v_add_f32 v224, v224, v225
    v_add_f32 v226, v226, v227
    v_add_f32 v228, v228, v229
    v_add_f32 v230, v230, v231
    v_add_f32 v224, v224, v226
    v_add_f32 v228, v228, v230
    v_add_f32 v224, v224, v228
    v_add_u32 v199, 92928, v190
    buffer_store_dword v196, v190, s[28:31], s49 offen offset:192
    buffer_store_dword v224, v199, s[28:31], s49 offen offset:192
    v_add_f32 v232, v232, v233
    v_add_f32 v234, v234, v235
    v_add_f32 v236, v236, v237
    v_add_f32 v238, v238, v239
    v_add_f32 v232, v232, v234
    v_add_f32 v236, v236, v238
    v_add_f32 v232, v232, v236
    v_add_u32 v199, 92928, v190
    buffer_store_dword v197, v190, s[28:31], s49 offen offset:256
    buffer_store_dword v232, v199, s[28:31], s49 offen offset:256
    v_add_f32 v240, v240, v241
    v_add_f32 v242, v242, v243
    v_add_f32 v244, v244, v245
    v_add_f32 v246, v246, v247
    v_add_f32 v240, v240, v242
    v_add_f32 v244, v244, v246
    v_add_f32 v240, v240, v244
    v_add_u32 v199, 92928, v191
    buffer_store_dword v198, v191, s[28:31], s49 offen offset:320
    buffer_store_dword v240, v199, s[28:31], s49 offen offset:320
L_svs_nostat:
    s_endpgm
L_svs_loader:
    s_sub_u32 s75, s36, 4
    s_lshl_b32 s75, s75, 10
    s_lshr_b32 s37, s75, 4
    v_add_u32 v3, s37, v1
    v_lshrrev_b32 v4, 3, v3
    v_xor_b32 v16, v4, v3
    v_and_b32 v16, 7, v16
    v_lshlrev_b32 v16, 4, v16
    v_add_u32 v4, s46, v4
    v_lshlrev_b32 v4, 7, v4
    v_add_u32 v16, v16, v4
    v_add_u32 v3, s37, v1
    v_add_u32 v3, 256, v3
    v_lshrrev_b32 v4, 3, v3
    v_xor_b32 v17, v4, v3
    v_and_b32 v17, 7, v17
    v_lshlrev_b32 v17, 4, v17
    v_add_u32 v4, s46, v4
    v_lshlrev_b32 v4, 7, v4
    v_add_u32 v17, v17, v4
    v_add_u32 v3, s37, v1
    v_add_u32 v3, 512, v3
    v_lshrrev_b32 v4, 3, v3
    v_xor_b32 v18, v4, v3
    v_and_b32 v18, 7, v18
    v_lshlrev_b32 v18, 4, v18
    v_add_u32 v4, s46, v4
    v_lshlrev_b32 v4, 7, v4
    v_add_u32 v18, v18, v4
    v_add_u32 v3, s37, v1
    v_add_u32 v3, 768, v3
    v_lshrrev_b32 v4, 3, v3
    v_xor_b32 v19, v4, v3
    v_and_b32 v19, 7, v19
    v_lshlrev_b32 v19, 4, v19
    v_add_u32 v4, s46, v4
    v_lshlrev_b32 v4, 7, v4
    v_add_u32 v19, v19, v4
    v_add_u32 v3, s37, v1
    v_add_u32 v3, 1024, v3
    v_lshrrev_b32 v4, 3, v3
    v_xor_b32 v20, v4, v3
    v_and_b32 v20, 7, v20
    v_lshlrev_b32 v20, 4, v20
    v_add_u32 v4, s46, v4
    v_lshlrev_b32 v4, 7, v4
    v_add_u32 v20, v20, v4
    v_add_u32 v3, s37, v1
    v_add_u32 v3, 1280, v3
    v_lshrrev_b32 v4, 3, v3
    v_xor_b32 v21, v4, v3
    v_and_b32 v21, 7, v21
    v_lshlrev_b32 v21, 4, v21
    v_add_u32 v4, s46, v4
    v_lshlrev_b32 v4, 7, v4
    v_add_u32 v21, v21, v4
    s_cmp_lt_u32 s75, 2048
    s_cselect_b32 s38, 0, 0x40000000
    v_add_u32 v21, s38, v21
    v_add_u32 v3, s37, v1
    v_lshrrev_b32 v4, 3, v3
    v_xor_b32 v22, v4, v3
    v_and_b32 v22, 7, v22
    v_lshlrev_b32 v22, 4, v22
    v_add_u32 v4, s47, v4
    v_lshlrev_b32 v4, 7, v4
    v_add_u32 v22, v22, v4
    v_add_u32 v3, s37, v1
    v_add_u32 v3, 256, v3
    v_lshrrev_b32 v4, 3, v3
    v_xor_b32 v23, v4, v3
    v_and_b32 v23, 7, v23
    v_lshlrev_b32 v23, 4, v23
    v_add_u32 v4, s47, v4
    v_lshlrev_b32 v4, 7, v4
    v_add_u32 v23, v23, v4
    v_add_u32 v3, s37, v1
    v_add_u32 v3, 512, v3
    v_lshrrev_b32 v4, 3, v3
    v_xor_b32 v24, v4, v3
    v_and_b32 v24, 7, v24
    v_lshlrev_b32 v24, 4, v24
    v_add_u32 v4, s47, v4
    v_lshlrev_b32 v4, 7, v4
    v_add_u32 v24, v24, v4
    s_waitcnt lgkmcnt(0)
    s_add_u32 s16, s8, 4259840
    s_addc_u32 s17, s9, 0
    s_mov_b32 s18, 3244032
    s_mov_b32 s19, 0x00020000
    s_add_u32 s20, s8, 8454144
    s_addc_u32 s21, s9, 0
    s_mov_b32 s22, 3244032
    s_mov_b32 s23, 0x00020000
    s_add_u32 s24, s8, 16842752
    s_addc_u32 s25, s9, 0
    s_mov_b32 s26, 4460544
    s_mov_b32 s27, 0x00020000
    s_add_u32 s28, s8, 25231360
    s_addc_u32 s29, s9, 0
    s_mov_b32 s30, 185856
    s_mov_b32 s31, 0x00020000
    s_mov_b32 s70, s75
    s_mul_i32 s72, s78, 270336
    s_mul_i32 s73, s78, 270336
    s_mov_b32 s74, 0
L_svs_ld0:
    s_add_u32 m0, s70, 0
    s_nop 0
    buffer_load_dwordx4 v16, s[16:19], s72 offen lds
    s_add_u32 m0, s70, 4096
    s_nop 0
    buffer_load_dwordx4 v17, s[16:19], s72 offen lds
    s_add_u32 m0, s70, 8192
    s_nop 0
    buffer_load_dwordx4 v18, s[16:19], s72 offen lds
    s_add_u32 m0, s70, 12288
    s_nop 0
    buffer_load_dwordx4 v19, s[16:19], s72 offen lds
    s_add_u32 m0, s70, 16384
    s_nop 0
    buffer_load_dwordx4 v20, s[16:19], s72 offen lds
    s_add_u32 m0, s70, 20480
    s_nop 0
    buffer_load_dwordx4 v21, s[16:19], s72 offen lds
    s_add_u32 m0, s70, 24576
    s_nop 0
    buffer_load_dwordx4 v22, s[20:23], s73 offen lds
    s_add_u32 m0, s70, 28672
    s_nop 0
    buffer_load_dwordx4 v23, s[20:23], s73 offen lds
    s_add_u32 m0, s70, 32768
    s_nop 0
    buffer_load_dwordx4 v24, s[20:23], s73 offen lds
    s_add_u32 s72, s72, 270336
    s_add_u32 s73, s73, 270336
    s_cmp_ge_u32 s72, 3244032
    s_cselect_b32 s72, 0, s72
    s_cselect_b32 s73, 0, s73
    s_add_u32 s70, s70, 36864
    s_cmp_ge_u32 s70, 147456
    s_cselect_b32 s38, 147456, 0
    s_sub_u32 s70, s70, s38
    s_add_u32 s74, s74, 1
    s_cmp_lt_u32 s74, 3
    s_cbranch_scc1 L_svs_ld0
    s_waitcnt vmcnt(18)
    s_barrier
L_svs_ld:
    s_waitcnt vmcnt(9)
    s_barrier
    s_cmp_ge_u32 s74, 12
    s_cselect_b32 s18, 0, s18
    s_cselect_b32 s22, 0, s22
    s_add_u32 m0, s70, 0
    s_nop 0
    buffer_load_dwordx4 v16, s[16:19], s72 offen lds
    s_add_u32 m0, s70, 4096
    s_nop 0
    buffer_load_dwordx4 v17, s[16:19], s72 offen lds
    s_add_u32 m0, s70, 8192
    s_nop 0
    buffer_load_dwordx4 v18, s[16:19], s72 offen lds
    s_add_u32 m0, s70, 12288
    s_nop 0
    buffer_load_dwordx4 v19, s[16:19], s72 offen lds
    s_add_u32 m0, s70, 16384
    s_nop 0
    buffer_load_dwordx4 v20, s[16:19], s72 offen lds
    s_add_u32 m0, s70, 20480
    s_nop 0
    buffer_load_dwordx4 v21, s[16:19], s72 offen lds
    s_add_u32 m0, s70, 24576
    s_nop 0
    buffer_load_dwordx4 v22, s[20:23], s73 offen lds
    s_add_u32 m0, s70, 28672
    s_nop 0
    buffer_load_dwordx4 v23, s[20:23], s73 offen lds
    s_add_u32 m0, s70, 32768
    s_nop 0
    buffer_load_dwordx4 v24, s[20:23], s73 offen lds
    s_add_u32 s72, s72, 270336
    s_add_u32 s73, s73, 270336
    s_cmp_ge_u32 s72, 3244032
    s_cselect_b32 s72, 0, s72
    s_cselect_b32 s73, 0, s73
    s_add_u32 s70, s70, 36864
    s_cmp_ge_u32 s70, 147456
    s_cselect_b32 s38, 147456, 0
    s_sub_u32 s70, s70, s38
    s_add_u32 s74, s74, 1
    s_cmp_lt_u32 s74, 15
    s_cbranch_scc1 L_svs_ld
    s_waitcnt vmcnt(0)
    s_endpgm
L_sv_vw:
    s_sub_u32 s42, s42, 66
    s_lshr_b32 s43, s42, 3
    s_and_b32 s44, s42, 7
    s_mul_i32 s55, s43, 176
    s_add_u32 s46, s55, s45
    s_mul_i32 s47, s44, 192
    s_lshl_b32 s48, s41, 3
    s_add_u32 s48, s48, s44
    s_mul_i32 s48, s48, 202752
    s_add_u32 s78, s43, s44
    s_mul_hi_u32 s79, s78, 357913942
    s_mul_i32 s79, s79, 12
    s_sub_u32 s78, s78, s79

    s_cmp_ge_u32 s36, 4
    s_cbranch_scc1 L_svw_loader
    v_lshrrev_b32 v2, 4, v1
    v_and_b32 v3, 15, v1
    s_lshr_b32 s76, s36, 1
    s_and_b32 s77, s36, 1
    s_mul_i32 s38, s76, 12288
    v_and_b32 v4, 7, v1
    v_xor_b32 v4, v4, v2
    v_lshlrev_b32 v4, 4, v4
    v_lshl_add_u32 v8, v3, 7, v4
    v_add_u32 v8, s38, v8
    v_and_b32 v4, 7, v1
    v_xor_b32 v4, v4, v2
    v_xor_b32 v4, 4, v4
    v_lshlrev_b32 v4, 4, v4
    v_lshl_add_u32 v9, v3, 7, v4
    v_add_u32 v9, s38, v9
    v_lshrrev_b32 v4, 1, v2
    v_lshlrev_b32 v4, 4, v4
    v_and_b32 v5, 1, v2
    v_lshl_add_u32 v4, v5, 2, v4
    v_lshrrev_b32 v6, 2, v3
    v_add_u32 v4, v4, v6
    v_lshl_add_u32 v6, v5, 2, v6
    s_mul_i32 s38, s77, 3
    s_add_u32 s39, s38, 0
    v_add_u32 v10, s39, v5
    v_subrev_u32 v7, 6, v10
    v_min_u32 v10, v10, v7
    v_lshlrev_b32 v10, 5, v10
    v_mul_u32_u24 v7, 192, v4
    v_add_u32 v10, v10, v7
    v_and_b32 v7, 3, v1
    v_lshl_add_u32 v10, v7, 3, v10
    v_add_u32 v10, 24576, v10
    s_add_u32 s39, s38, 1
    v_add_u32 v11, s39, v5
    v_subrev_u32 v7, 6, v11
    v_min_u32 v11, v11, v7
    v_lshlrev_b32 v11, 5, v11
    v_mul_u32_u24 v7, 192, v4
    v_add_u32 v11, v11, v7
    v_and_b32 v7, 3, v1
    v_lshl_add_u32 v11, v7, 3, v11
    v_add_u32 v11, 24576, v11
    s_add_u32 s39, s38, 2
    v_add_u32 v12, s39, v5
    v_subrev_u32 v7, 6, v12
    v_min_u32 v12, v12, v7
    v_lshlrev_b32 v12, 5, v12
    v_mul_u32_u24 v7, 192, v4
    v_add_u32 v12, v12, v7
    v_and_b32 v7, 3, v1
    v_lshl_add_u32 v12, v7, 3, v12
    v_add_u32 v12, 24576, v12
    v_mov_b32 v96, 0
    v_mov_b32 v97, 0
    v_mov_b32 v98, 0
    v_mov_b32 v99, 0
    v_mov_b32 v100, 0
    v_mov_b32 v101, 0
    v_mov_b32 v102, 0
    v_mov_b32 v103, 0
    v_mov_b32 v104, 0
    v_mov_b32 v105, 0
    v_mov_b32 v106, 0
    v_mov_b32 v107, 0
    v_mov_b32 v108, 0
    v_mov_b32 v109, 0
    v_mov_b32 v110, 0
    v_mov_b32 v111, 0
    v_mov_b32 v112, 0
    v_mov_b32 v113, 0
    v_mov_b32 v114, 0
    v_mov_b32 v115, 0
    v_mov_b32 v116, 0
    v_mov_b32 v117, 0
    v_mov_b32 v118, 0
    v_mov_b32 v119, 0
    v_mov_b32 v120, 0
    v_mov_b32 v121, 0
    v_mov_b32 v122, 0
    v_mov_b32 v123, 0
    v_mov_b32 v124, 0
    v_mov_b32 v125, 0
    v_mov_b32 v126, 0
    v_mov_b32 v127, 0
    v_mov_b32 v128, 0
    v_mov_b32 v129, 0
    v_mov_b32 v130, 0
    v_mov_b32 v131, 0
    v_mov_b32 v132, 0
    v_mov_b32 v133, 0
    v_mov_b32 v134, 0
    v_mov_b32 v135, 0
    v_mov_b32 v136, 0
    v_mov_b32 v137, 0
    v_mov_b32 v138, 0
    v_mov_b32 v139, 0
    v_mov_b32 v140, 0
    v_mov_b32 v141, 0
    v_mov_b32 v142, 0
    v_mov_b32 v143, 0
    v_mov_b32 v144, 0
    v_mov_b32 v145, 0
    v_mov_b32 v146, 0
    v_mov_b32 v147, 0
    v_mov_b32 v148, 0
    v_mov_b32 v149, 0
    v_mov_b32 v150, 0
    v_mov_b32 v151, 0
    v_mov_b32 v152, 0
    v_mov_b32 v153, 0
    v_mov_b32 v154, 0
    v_mov_b32 v155, 0
    v_mov_b32 v156, 0
    v_mov_b32 v157, 0
    v_mov_b32 v158, 0
    v_mov_b32 v159, 0
    v_mov_b32 v160, 0
    v_mov_b32 v161, 0
    v_mov_b32 v162, 0
    v_mov_b32 v163, 0
    v_mov_b32 v164, 0
    v_mov_b32 v165, 0
    v_mov_b32 v166, 0
    v_mov_b32 v167, 0
    s_waitcnt lgkmcnt(0)
    s_add_u32 s16, s8, 12648448
    s_addc_u32 s17, s9, 0
    s_mov_b32 s18, 3244032
    s_mov_b32 s19, 0x00020000
    s_mov_b32 s20, s12
    s_mov_b32 s21, s13
    s_mov_b32 s22, 1179648
    s_mov_b32 s23, 0x00020000
    s_add_u32 s24, s8, 26279936
    s_addc_u32 s25, s9, 0
    s_mov_b32 s26, 3244032
    s_mov_b32 s27, 0x00020000
    s_mul_i32 s38, s77, 96
    v_and_b32 v168, 1, v2
    v_lshlrev_b32 v168, 5, v168
    v_lshrrev_b32 v170, 1, v2
    v_lshl_add_u32 v168, v170, 4, v168
    v_add_u32 v168, s38, v168
    v_lshlrev_b32 v169, 3, v2
    v_add_u32 v169, s38, v169
    s_mul_i32 s39, s76, 96
    s_add_u32 s51, s39, s55
    v_add_u32 v192, s51, v3
    v_mul_u32_u24 v192, 192, v192
    v_add_u32 v180, v192, v168
    v_add_u32 v186, v192, v169
    v_add_u32 v192, s51, v3
    v_add_u32 v192, 16, v192
    v_mul_u32_u24 v192, 192, v192
    v_add_u32 v181, v192, v168
    v_add_u32 v187, v192, v169
    v_add_u32 v192, s51, v3
    v_add_u32 v192, 32, v192
    v_mul_u32_u24 v192, 192, v192
    v_add_u32 v182, v192, v168
    v_add_u32 v188, v192, v169
    v_add_u32 v192, s51, v3
    v_add_u32 v192, 48, v192
    v_mul_u32_u24 v192, 192, v192
    v_add_u32 v183, v192, v168
    v_add_u32 v189, v192, v169
    v_add_u32 v192, s51, v3
    v_add_u32 v192, 64, v192
    v_mul_u32_u24 v192, 192, v192
    v_add_u32 v184, v192, v168
    v_add_u32 v190, v192, v169
    v_add_u32 v192, s51, v3
    v_add_u32 v192, 80, v192
    v_mul_u32_u24 v192, 192, v192
    s_cmp_eq_u32 s76, 1
    s_cselect_b32 s38, 0x7ffffff, 0
    v_add_u32 v192, s38, v192
    v_add_u32 v185, v192, v168
    v_add_u32 v191, v192, v169
    s_mov_b32 s70, 0
    s_mov_b32 s71, 0
    v_add_u32 v13, s70, v8
    v_add_u32 v14, s70, v9
    v_add_u32 v15, s71, v8
    v_add_u32 v16, s70, v10
    v_add_u32 v17, s70, v11
    v_add_u32 v18, s70, v12
    v_add_u32 v19, s71, v10
    v_add_u32 v20, s71, v11
    v_add_u32 v21, s71, v12
    s_barrier
    ds_read_b128 v[24:27], v15 offset:0
    ds_read_b128 v[28:31], v15 offset:2048
    ds_read_b128 v[32:35], v15 offset:4096
    ds_read_b128 v[36:39], v15 offset:6144
    ds_read_b128 v[40:43], v15 offset:8192
    ds_read_b128 v[44:47], v15 offset:10240
    ds_read_b64_tr_b16 v[72:73], v19 offset:0
    ds_read_b64_tr_b16 v[74:75], v19 offset:1536
    ds_read_b64_tr_b16 v[76:77], v20 offset:0
    ds_read_b64_tr_b16 v[78:79], v20 offset:1536
    ds_read_b64_tr_b16 v[80:81], v21 offset:0
    ds_read_b64_tr_b16 v[82:83], v21 offset:1536
    s_mov_b32 s71, 36864
    s_mov_b32 s74, 0
L_svw_cl:
    s_barrier
    v_add_u32 v13, s70, v8
    v_add_u32 v14, s70, v9
    v_add_u32 v15, s71, v8
    v_add_u32 v16, s70, v10
    v_add_u32 v17, s70, v11
    v_add_u32 v18, s70, v12
    v_add_u32 v19, s71, v10
    v_add_u32 v20, s71, v11
    v_add_u32 v21, s71, v12
    s_waitcnt lgkmcnt(0)
    v_mfma_f32_16x16x32_bf16 v[96:99], v[72:75], v[24:27], v[96:99]
    ds_read_b128 v[48:51], v14 offset:0
    v_mfma_f32_16x16x32_bf16 v[100:103], v[76:79], v[24:27], v[100:103]
    ds_read_b128 v[52:55], v14 offset:2048
    v_mfma_f32_16x16x32_bf16 v[104:107], v[80:83], v[24:27], v[104:107]
    v_mfma_f32_16x16x32_bf16 v[108:111], v[72:75], v[28:31], v[108:111]
    ds_read_b128 v[56:59], v14 offset:4096
    v_mfma_f32_16x16x32_bf16 v[112:115], v[76:79], v[28:31], v[112:115]
    ds_read_b128 v[60:63], v14 offset:6144
    v_mfma_f32_16x16x32_bf16 v[116:119], v[80:83], v[28:31], v[116:119]
    v_mfma_f32_16x16x32_bf16 v[120:123], v[72:75], v[32:35], v[120:123]
    ds_read_b128 v[64:67], v14 offset:8192
    v_mfma_f32_16x16x32_bf16 v[124:127], v[76:79], v[32:35], v[124:127]
    ds_read_b128 v[68:71], v14 offset:10240
    v_mfma_f32_16x16x32_bf16 v[128:131], v[80:83], v[32:35], v[128:131]
    v_mfma_f32_16x16x32_bf16 v[132:135], v[72:75], v[36:39], v[132:135]
    ds_read_b64_tr_b16 v[84:85], v16 offset:6144
    v_mfma_f32_16x16x32_bf16 v[136:139], v[76:79], v[36:39], v[136:139]
    ds_read_b64_tr_b16 v[86:87], v16 offset:7680
    v_mfma_f32_16x16x32_bf16 v[140:143], v[80:83], v[36:39], v[140:143]
    v_mfma_f32_16x16x32_bf16 v[144:147], v[72:75], v[40:43], v[144:147]
    ds_read_b64_tr_b16 v[88:89], v17 offset:6144
    v_mfma_f32_16x16x32_bf16 v[148:151], v[76:79], v[40:43], v[148:151]
    ds_read_b64_tr_b16 v[90:91], v17 offset:7680
    v_mfma_f32_16x16x32_bf16 v[152:155], v[80:83], v[40:43], v[152:155]
    v_mfma_f32_16x16x32_bf16 v[156:159], v[72:75], v[44:47], v[156:159]
    ds_read_b64_tr_b16 v[92:93], v18 offset:6144
    v_mfma_f32_16x16x32_bf16 v[160:163], v[76:79], v[44:47], v[160:163]
    ds_read_b64_tr_b16 v[94:95], v18 offset:7680
    v_mfma_f32_16x16x32_bf16 v[164:167], v[80:83], v[44:47], v[164:167]
    s_waitcnt lgkmcnt(0)
    v_mfma_f32_16x16x32_bf16 v[96:99], v[84:87], v[48:51], v[96:99]
    ds_read_b128 v[24:27], v15 offset:0
    v_mfma_f32_16x16x32_bf16 v[100:103], v[88:91], v[48:51], v[100:103]
    ds_read_b128 v[28:31], v15 offset:2048
    v_mfma_f32_16x16x32_bf16 v[104:107], v[92:95], v[48:51], v[104:107]
    v_mfma_f32_16x16x32_bf16 v[108:111], v[84:87], v[52:55], v[108:111]
    ds_read_b128 v[32:35], v15 offset:4096
    v_mfma_f32_16x16x32_bf16 v[112:115], v[88:91], v[52:55], v[112:115]
    ds_read_b128 v[36:39], v15 offset:6144
    v_mfma_f32_16x16x32_bf16 v[116:119], v[92:95], v[52:55], v[116:119]
    v_mfma_f32_16x16x32_bf16 v[120:123], v[84:87], v[56:59], v[120:123]
    ds_read_b128 v[40:43], v15 offset:8192
    v_mfma_f32_16x16x32_bf16 v[124:127], v[88:91], v[56:59], v[124:127]
    ds_read_b128 v[44:47], v15 offset:10240
    v_mfma_f32_16x16x32_bf16 v[128:131], v[92:95], v[56:59], v[128:131]
    v_mfma_f32_16x16x32_bf16 v[132:135], v[84:87], v[60:63], v[132:135]
    ds_read_b64_tr_b16 v[72:73], v19 offset:0
    v_mfma_f32_16x16x32_bf16 v[136:139], v[88:91], v[60:63], v[136:139]
    ds_read_b64_tr_b16 v[74:75], v19 offset:1536
    v_mfma_f32_16x16x32_bf16 v[140:143], v[92:95], v[60:63], v[140:143]
    v_mfma_f32_16x16x32_bf16 v[144:147], v[84:87], v[64:67], v[144:147]
    ds_read_b64_tr_b16 v[76:77], v20 offset:0
    v_mfma_f32_16x16x32_bf16 v[148:151], v[88:91], v[64:67], v[148:151]
    ds_read_b64_tr_b16 v[78:79], v20 offset:1536
    v_mfma_f32_16x16x32_bf16 v[152:155], v[92:95], v[64:67], v[152:155]
    v_mfma_f32_16x16x32_bf16 v[156:159], v[84:87], v[68:71], v[156:159]
    ds_read_b64_tr_b16 v[80:81], v21 offset:0
    v_mfma_f32_16x16x32_bf16 v[160:163], v[88:91], v[68:71], v[160:163]
    ds_read_b64_tr_b16 v[82:83], v21 offset:1536
    v_mfma_f32_16x16x32_bf16 v[164:167], v[92:95], v[68:71], v[164:167]
    s_mov_b32 s70, s71
    s_add_u32 s71, s71, 36864
    s_cmp_ge_u32 s71, 147456
    s_cselect_b32 s71, 0, s71
    s_add_u32 s74, s74, 1
    s_cmp_lt_u32 s74, 12
    s_cbranch_scc1 L_svw_cl
L_svw_cx:
    s_waitcnt lgkmcnt(0)
    s_nop 9
    v_cvt_pk_bf16_f32 v172, v96, v97
    v_cvt_pk_bf16_f32 v173, v98, v99
    v_cvt_pk_bf16_f32 v174, v100, v101
    v_cvt_pk_bf16_f32 v175, v102, v103
    s_nop 1
    v_permlane16_swap_b32 v172, v174
    v_permlane16_swap_b32 v173, v175
    buffer_store_dwordx4 v[172:175], v180, s[24:27], s48 offen offset:0
    v_cvt_pk_bf16_f32 v176, v104, v105
    v_cvt_pk_bf16_f32 v177, v106, v107
    buffer_store_dwordx2 v[176:177], v186, s[24:27], s48 offen offset:64
    v_cvt_pk_bf16_f32 v172, v108, v109
    v_cvt_pk_bf16_f32 v173, v110, v111
    v_cvt_pk_bf16_f32 v174, v112, v113
    v_cvt_pk_bf16_f32 v175, v114, v115
    s_nop 1
    v_permlane16_swap_b32 v172, v174
    v_permlane16_swap_b32 v173, v175
    buffer_store_dwordx4 v[172:175], v181, s[24:27], s48 offen offset:0
    v_cvt_pk_bf16_f32 v176, v116, v117
    v_cvt_pk_bf16_f32 v177, v118, v119
    buffer_store_dwordx2 v[176:177], v187, s[24:27], s48 offen offset:64
    v_cvt_pk_bf16_f32 v172, v120, v121
    v_cvt_pk_bf16_f32 v173, v122, v123
    v_cvt_pk_bf16_f32 v174, v124, v125
    v_cvt_pk_bf16_f32 v175, v126, v127
    s_nop 1
    v_permlane16_swap_b32 v172, v174
    v_permlane16_swap_b32 v173, v175
    buffer_store_dwordx4 v[172:175], v182, s[24:27], s48 offen offset:0
    v_cvt_pk_bf16_f32 v176, v128, v129
    v_cvt_pk_bf16_f32 v177, v130, v131
    buffer_store_dwordx2 v[176:177], v188, s[24:27], s48 offen offset:64
    v_cvt_pk_bf16_f32 v172, v132, v133
    v_cvt_pk_bf16_f32 v173, v134, v135
    v_cvt_pk_bf16_f32 v174, v136, v137
    v_cvt_pk_bf16_f32 v175, v138, v139
    s_nop 1
    v_permlane16_swap_b32 v172, v174
    v_permlane16_swap_b32 v173, v175
    buffer_store_dwordx4 v[172:175], v183, s[24:27], s48 offen offset:0
    v_cvt_pk_bf16_f32 v176, v140, v141
    v_cvt_pk_bf16_f32 v177, v142, v143
    buffer_store_dwordx2 v[176:177], v189, s[24:27], s48 offen offset:64
    v_cvt_pk_bf16_f32 v172, v144, v145
    v_cvt_pk_bf16_f32 v173, v146, v147
    v_cvt_pk_bf16_f32 v174, v148, v149
    v_cvt_pk_bf16_f32 v175, v150, v151
    s_nop 1
    v_permlane16_swap_b32 v172, v174
    v_permlane16_swap_b32 v173, v175
    buffer_store_dwordx4 v[172:175], v184, s[24:27], s48 offen offset:0
    v_cvt_pk_bf16_f32 v176, v152, v153
    v_cvt_pk_bf16_f32 v177, v154, v155
    buffer_store_dwordx2 v[176:177], v190, s[24:27], s48 offen offset:64
    v_cvt_pk_bf16_f32 v172, v156, v157
    v_cvt_pk_bf16_f32 v173, v158, v159
    v_cvt_pk_bf16_f32 v174, v160, v161
    v_cvt_pk_bf16_f32 v175, v162, v163
    s_nop 1
    v_permlane16_swap_b32 v172, v174
    v_permlane16_swap_b32 v173, v175
    buffer_store_dwordx4 v[172:175], v185, s[24:27], s48 offen offset:0
    v_cvt_pk_bf16_f32 v176, v164, v165
    v_cvt_pk_bf16_f32 v177, v166, v167
    buffer_store_dwordx2 v[176:177], v191, s[24:27], s48 offen offset:64
    s_endpgm
L_svw_loader:
    s_sub_u32 s75, s36, 4
    s_lshl_b32 s75, s75, 10
    s_lshr_b32 s37, s75, 4
    v_add_u32 v3, s37, v1
    v_lshrrev_b32 v4, 3, v3
    v_xor_b32 v16, v4, v3
    v_and_b32 v16, 7, v16
    v_lshlrev_b32 v16, 4, v16
    v_add_u32 v4, s46, v4
    v_lshlrev_b32 v4, 7, v4
    v_add_u32 v16, v16, v4
    v_add_u32 v3, s37, v1
    v_add_u32 v3, 256, v3
    v_lshrrev_b32 v4, 3, v3
    v_xor_b32 v17, v4, v3
    v_and_b32 v17, 7, v17
    v_lshlrev_b32 v17, 4, v17
    v_add_u32 v4, s46, v4
    v_lshlrev_b32 v4, 7, v4
    v_add_u32 v17, v17, v4
    v_add_u32 v3, s37, v1
    v_add_u32 v3, 512, v3
    v_lshrrev_b32 v4, 3, v3
    v_xor_b32 v18, v4, v3
    v_and_b32 v18, 7, v18
    v_lshlrev_b32 v18, 4, v18
    v_add_u32 v4, s46, v4
    v_lshlrev_b32 v4, 7, v4
    v_add_u32 v18, v18, v4
    v_add_u32 v3, s37, v1
    v_add_u32 v3, 768, v3
    v_lshrrev_b32 v4, 3, v3
    v_xor_b32 v19, v4, v3
    v_and_b32 v19, 7, v19
    v_lshlrev_b32 v19, 4, v19
    v_add_u32 v4, s46, v4
    v_lshlrev_b32 v4, 7, v4
    v_add_u32 v19, v19, v4
    v_add_u32 v3, s37, v1
    v_add_u32 v3, 1024, v3
    v_lshrrev_b32 v4, 3, v3
    v_xor_b32 v20, v4, v3
    v_and_b32 v20, 7, v20
    v_lshlrev_b32 v20, 4, v20
    v_add_u32 v4, s46, v4
    v_lshlrev_b32 v4, 7, v4
    v_add_u32 v20, v20, v4
    v_add_u32 v3, s37, v1
    v_add_u32 v3, 1280, v3
    v_lshrrev_b32 v4, 3, v3
    v_xor_b32 v21, v4, v3
    v_and_b32 v21, 7, v21
    v_lshlrev_b32 v21, 4, v21
    v_add_u32 v4, s46, v4
    v_lshlrev_b32 v4, 7, v4
    v_add_u32 v21, v21, v4
    s_cmp_lt_u32 s75, 2048
    s_cselect_b32 s38, 0, 0x40000000
    v_add_u32 v21, s38, v21
    v_add_u32 v3, s37, v1
    v_mul_u32_u24 v6, 43691, v3
    v_lshrrev_b32 v6, 19, v6
    v_mul_u32_u24 v7, 12, v6
    v_sub_u32 v5, v3, v7
    v_lshrrev_b32 v7, 1, v5
    v_bfe_u32 v22, v6, 2, 1
    v_sub_u32 v7, v7, v22
    v_add_u32 v22, 6, v7
    v_min_u32 v7, v7, v22
    v_lshlrev_b32 v7, 5, v7
    v_and_b32 v5, 1, v5
    v_lshl_add_u32 v22, v5, 4, v7
    v_and_b32 v4, 0xfffffff3, v6
    v_bfe_u32 v5, v6, 2, 1
    v_bfe_u32 v7, v6, 3, 1
    v_lshl_or_b32 v4, v5, 3, v4
    v_lshl_or_b32 v4, v7, 2, v4
    v_mul_u32_u24 v4, 1536, v4
    v_add_u32 v4, s47, v4
    v_add_u32 v22, v22, v4
    v_add_u32 v3, s37, v1
    v_add_u32 v3, 256, v3
    v_mul_u32_u24 v6, 43691, v3
    v_lshrrev_b32 v6, 19, v6
    v_mul_u32_u24 v7, 12, v6
    v_sub_u32 v5, v3, v7
    v_lshrrev_b32 v7, 1, v5
    v_bfe_u32 v23, v6, 2, 1
    v_sub_u32 v7, v7, v23
    v_add_u32 v23, 6, v7
    v_min_u32 v7, v7, v23
    v_lshlrev_b32 v7, 5, v7
    v_and_b32 v5, 1, v5
    v_lshl_add_u32 v23, v5, 4, v7
    v_and_b32 v4, 0xfffffff3, v6
    v_bfe_u32 v5, v6, 2, 1
    v_bfe_u32 v7, v6, 3, 1
    v_lshl_or_b32 v4, v5, 3, v4
    v_lshl_or_b32 v4, v7, 2, v4
    v_mul_u32_u24 v4, 1536, v4
    v_add_u32 v4, s47, v4
    v_add_u32 v23, v23, v4
    v_add_u32 v3, s37, v1
    v_add_u32 v3, 512, v3
    v_mul_u32_u24 v6, 43691, v3
    v_lshrrev_b32 v6, 19, v6
    v_mul_u32_u24 v7, 12, v6
    v_sub_u32 v5, v3, v7
    v_lshrrev_b32 v7, 1, v5
    v_bfe_u32 v24, v6, 2, 1
    v_sub_u32 v7, v7, v24
    v_add_u32 v24, 6, v7
    v_min_u32 v7, v7, v24
    v_lshlrev_b32 v7, 5, v7
    v_and_b32 v5, 1, v5
    v_lshl_add_u32 v24, v5, 4, v7
    v_and_b32 v4, 0xfffffff3, v6
    v_bfe_u32 v5, v6, 2, 1
    v_bfe_u32 v7, v6, 3, 1
    v_lshl_or_b32 v4, v5, 3, v4
    v_lshl_or_b32 v4, v7, 2, v4
    v_mul_u32_u24 v4, 1536, v4
    v_add_u32 v4, s47, v4
    v_add_u32 v24, v24, v4
    s_waitcnt lgkmcnt(0)
    s_add_u32 s16, s8, 12648448
    s_addc_u32 s17, s9, 0
    s_mov_b32 s18, 3244032
    s_mov_b32 s19, 0x00020000
    s_mov_b32 s20, s12
    s_mov_b32 s21, s13
    s_mov_b32 s22, 1179648
    s_mov_b32 s23, 0x00020000
    s_add_u32 s24, s8, 26279936
    s_addc_u32 s25, s9, 0
    s_mov_b32 s26, 3244032
    s_mov_b32 s27, 0x00020000
    s_mov_b32 s70, s75
    s_mul_i32 s72, s78, 270336
    s_mul_i32 s73, s78, 98304
    s_mov_b32 s74, 0
L_svw_ld0:
    s_add_u32 m0, s70, 0
    s_nop 0
    buffer_load_dwordx4 v16, s[16:19], s72 offen lds
    s_add_u32 m0, s70, 4096
    s_nop 0
    buffer_load_dwordx4 v17, s[16:19], s72 offen lds
    s_add_u32 m0, s70, 8192
    s_nop 0
    buffer_load_dwordx4 v18, s[16:19], s72 offen lds
    s_add_u32 m0, s70, 12288
    s_nop 0
    buffer_load_dwordx4 v19, s[16:19], s72 offen lds
    s_add_u32 m0, s70, 16384
    s_nop 0
    buffer_load_dwordx4 v20, s[16:19], s72 offen lds
    s_add_u32 m0, s70, 20480
    s_nop 0
    buffer_load_dwordx4 v21, s[16:19], s72 offen lds
    s_add_u32 m0, s70, 24576
    s_nop 0
    buffer_load_dwordx4 v22, s[20:23], s73 offen lds
    s_add_u32 m0, s70, 28672
    s_nop 0
    buffer_load_dwordx4 v23, s[20:23], s73 offen lds
    s_add_u32 m0, s70, 32768
    s_nop 0
    buffer_load_dwordx4 v24, s[20:23], s73 offen lds
    s_add_u32 s72, s72, 270336
    s_add_u32 s73, s73, 98304
    s_cmp_ge_u32 s72, 3244032
    s_cselect_b32 s72, 0, s72
    s_cselect_b32 s73, 0, s73
    s_add_u32 s70, s70, 36864
    s_cmp_ge_u32 s70, 147456
    s_cselect_b32 s38, 147456, 0
    s_sub_u32 s70, s70, s38
    s_add_u32 s74, s74, 1
    s_cmp_lt_u32 s74, 3
    s_cbranch_scc1 L_svw_ld0
    s_waitcnt vmcnt(18)
    s_barrier
L_svw_ld:
    s_waitcnt vmcnt(9)
    s_barrier
    s_cmp_ge_u32 s74, 12
    s_cselect_b32 s18, 0, s18
    s_cselect_b32 s22, 0, s22
    s_add_u32 m0, s70, 0
    s_nop 0
    buffer_load_dwordx4 v16, s[16:19], s72 offen lds
    s_add_u32 m0, s70, 4096
    s_nop 0
    buffer_load_dwordx4 v17, s[16:19], s72 offen lds
    s_add_u32 m0, s70, 8192
    s_nop 0
    buffer_load_dwordx4 v18, s[16:19], s72 offen lds
    s_add_u32 m0, s70, 12288
    s_nop 0
    buffer_load_dwordx4 v19, s[16:19], s72 offen lds
    s_add_u32 m0, s70, 16384
    s_nop 0
    buffer_load_dwordx4 v20, s[16:19], s72 offen lds
    s_add_u32 m0, s70, 20480
    s_nop 0
    buffer_load_dwordx4 v21, s[16:19], s72 offen lds
    s_add_u32 m0, s70, 24576
    s_nop 0
    buffer_load_dwordx4 v22, s[20:23], s73 offen lds
    s_add_u32 m0, s70, 28672
    s_nop 0
    buffer_load_dwordx4 v23, s[20:23], s73 offen lds
    s_add_u32 m0, s70, 32768
    s_nop 0
    buffer_load_dwordx4 v24, s[20:23], s73 offen lds
    s_add_u32 s72, s72, 270336
    s_add_u32 s73, s73, 98304
    s_cmp_ge_u32 s72, 3244032
    s_cselect_b32 s72, 0, s72
    s_cselect_b32 s73, 0, s73
    s_add_u32 s70, s70, 36864
    s_cmp_ge_u32 s70, 147456
    s_cselect_b32 s38, 147456, 0
    s_sub_u32 s70, s70, s38
    s_add_u32 s74, s74, 1
    s_cmp_lt_u32 s74, 15
    s_cbranch_scc1 L_svw_ld
    s_waitcnt vmcnt(0)
    s_endpgm
L_sv_end:
    s_endpgm
.globl fo_kernel
.p2align 8
.type fo_kernel,@function
fo_kernel:
    s_cmp_lt_u32 s2, 48
    s_cbranch_scc1 L_fo_t2
    s_cmp_ge_u32 s2, 256
    s_cbranch_scc1 L_fo_end
    s_load_dwordx2 s[4:5], s[0:1], 0
    s_load_dwordx2 s[10:11], s[0:1], 72
    s_load_dwordx2 s[8:9], s[0:1], 88
    s_sub_u32 s39, s2, 48
    s_and_b32 s40, s39, 7
    s_lshr_b32 s41, s39, 3
    s_mul_i32 s40, s40, 26
    s_add_u32 s40, s40, s41
    s_cmp_ge_u32 s40, 104
    s_cselect_b32 s41, 1, 0
    s_mul_i32 s42, s41, 104
    s_sub_u32 s42, s40, s42
    s_add_u32 s42, s42, 8

    s_and_b32 s44, s42, 7
    s_lshr_b32 s43, s42, 3
    s_mul_i32 s46, s43, 80
    s_sub_u32 s46, s46, 48
    s_mov_b32 s54, 1055
    s_mov_b32 s55, 13631488
    s_cmp_eq_u32 s43, 0
    s_cselect_b32 s46, 0, s46
    s_cselect_b32 s54, 31, s54
    s_cselect_b32 s55, 0, s55
    s_mul_i32 s45, s41, 1056
    s_mul_i32 s47, s44, 192
    s_lshl_b32 s48, s41, 3
    s_add_u32 s48, s48, s44
    s_mul_i32 s48, s48, 202752
    s_mul_i32 s55, s41, 2230272
    s_mul_i32 s49, s41, 46464
    s_mov_b32 s78, 0

    v_lshrrev_b32 v2, 6, v0
    v_and_b32 v1, 63, v0
    s_nop 0
    v_readfirstlane_b32 s36, v2
    s_nop 3
    s_cmp_ge_u32 s36, 4
    s_cbranch_scc1 L_fo_loader
    v_lshrrev_b32 v2, 4, v1
    v_and_b32 v3, 15, v1
    s_lshr_b32 s76, s36, 1
    s_and_b32 s77, s36, 1
    s_mul_i32 s38, s76, 9216
    v_lshrrev_b32 v4, 2, v3
    v_sub_u32 v4, 0, v4
    v_and_b32 v4, 3, v4
    v_xor_b32 v4, v4, v2
    v_lshlrev_b32 v4, 4, v4
    v_mul_u32_u24 v5, 192, v3
    v_add_u32 v8, v4, v5
    v_add_u32 v8, s38, v8
    v_lshrrev_b32 v4, 1, v2
    v_lshlrev_b32 v4, 4, v4
    v_and_b32 v5, 1, v2
    v_lshl_add_u32 v4, v5, 2, v4
    v_lshrrev_b32 v6, 2, v3
    v_add_u32 v4, v4, v6
    v_lshl_add_u32 v6, v5, 2, v6
    s_mul_i32 s38, s77, 3
    s_add_u32 s39, s38, 0
    v_add_u32 v9, s39, v5
    v_subrev_u32 v7, 6, v9
    v_min_u32 v9, v9, v7
    v_lshlrev_b32 v9, 5, v9
    v_mul_u32_u24 v7, 192, v4
    v_add_u32 v9, v9, v7
    v_and_b32 v7, 3, v1
    v_lshl_add_u32 v9, v7, 3, v9
    v_add_u32 v9, 16384, v9
    s_add_u32 s39, s38, 1
    v_add_u32 v10, s39, v5
    v_subrev_u32 v7, 6, v10
    v_min_u32 v10, v10, v7
    v_lshlrev_b32 v10, 5, v10
    v_mul_u32_u24 v7, 192, v4
    v_add_u32 v10, v10, v7
    v_and_b32 v7, 3, v1
    v_lshl_add_u32 v10, v7, 3, v10
    v_add_u32 v10, 16384, v10
    s_add_u32 s39, s38, 2
    v_add_u32 v11, s39, v5
    v_subrev_u32 v7, 6, v11
    v_min_u32 v11, v11, v7
    v_lshlrev_b32 v11, 5, v11
    v_mul_u32_u24 v7, 192, v4
    v_add_u32 v11, v11, v7
    v_and_b32 v7, 3, v1
    v_lshl_add_u32 v11, v7, 3, v11
    v_add_u32 v11, 16384, v11
    v_mov_b32 v68, 0
    v_mov_b32 v104, 0
    v_mov_b32 v140, 0
    v_mov_b32 v69, 0
    v_mov_b32 v105, 0
    v_mov_b32 v141, 0
    v_mov_b32 v70, 0
    v_mov_b32 v106, 0
    v_mov_b32 v142, 0
    v_mov_b32 v71, 0
    v_mov_b32 v107, 0
    v_mov_b32 v143, 0
    v_mov_b32 v72, 0
    v_mov_b32 v108, 0
    v_mov_b32 v144, 0
    v_mov_b32 v73, 0
    v_mov_b32 v109, 0
    v_mov_b32 v145, 0
    v_mov_b32 v74, 0
    v_mov_b32 v110, 0
    v_mov_b32 v146, 0
    v_mov_b32 v75, 0
    v_mov_b32 v111, 0
    v_mov_b32 v147, 0
    v_mov_b32 v76, 0
    v_mov_b32 v112, 0
    v_mov_b32 v148, 0
    v_mov_b32 v77, 0
    v_mov_b32 v113, 0
    v_mov_b32 v149, 0
    v_mov_b32 v78, 0
    v_mov_b32 v114, 0
    v_mov_b32 v150, 0
    v_mov_b32 v79, 0
    v_mov_b32 v115, 0
    v_mov_b32 v151, 0
    v_mov_b32 v80, 0
    v_mov_b32 v116, 0
    v_mov_b32 v152, 0
    v_mov_b32 v81, 0
    v_mov_b32 v117, 0
    v_mov_b32 v153, 0
    v_mov_b32 v82, 0
    v_mov_b32 v118, 0
    v_mov_b32 v154, 0
    v_mov_b32 v83, 0
    v_mov_b32 v119, 0
    v_mov_b32 v155, 0
    v_mov_b32 v84, 0
    v_mov_b32 v120, 0
    v_mov_b32 v156, 0
    v_mov_b32 v85, 0
    v_mov_b32 v121, 0
    v_mov_b32 v157, 0
    v_mov_b32 v86, 0
    v_mov_b32 v122, 0
    v_mov_b32 v158, 0
    v_mov_b32 v87, 0
    v_mov_b32 v123, 0
    v_mov_b32 v159, 0
    v_mov_b32 v88, 0
    v_mov_b32 v124, 0
    v_mov_b32 v160, 0
    v_mov_b32 v89, 0
    v_mov_b32 v125, 0
    v_mov_b32 v161, 0
    v_mov_b32 v90, 0
    v_mov_b32 v126, 0
    v_mov_b32 v162, 0
    v_mov_b32 v91, 0
    v_mov_b32 v127, 0
    v_mov_b32 v163, 0
    v_mov_b32 v92, 0
    v_mov_b32 v128, 0
    v_mov_b32 v164, 0
    v_mov_b32 v93, 0
    v_mov_b32 v129, 0
    v_mov_b32 v165, 0
    v_mov_b32 v94, 0
    v_mov_b32 v130, 0
    v_mov_b32 v166, 0
    v_mov_b32 v95, 0
    v_mov_b32 v131, 0
    v_mov_b32 v167, 0
    v_mov_b32 v96, 0
    v_mov_b32 v132, 0
    v_mov_b32 v168, 0
    v_mov_b32 v97, 0
    v_mov_b32 v133, 0
    v_mov_b32 v169, 0
    v_mov_b32 v98, 0
    v_mov_b32 v134, 0
    v_mov_b32 v170, 0
    v_mov_b32 v99, 0
    v_mov_b32 v135, 0
    v_mov_b32 v171, 0
    v_mov_b32 v100, 0
    v_mov_b32 v136, 0
    v_mov_b32 v172, 0
    v_mov_b32 v101, 0
    v_mov_b32 v137, 0
    v_mov_b32 v173, 0
    v_mov_b32 v102, 0
    v_mov_b32 v138, 0
    v_mov_b32 v174, 0
    v_mov_b32 v103, 0
    v_mov_b32 v139, 0
    v_mov_b32 v175, 0
    s_waitcnt lgkmcnt(0)
    s_add_u32 s16, s8, 16842752
    s_addc_u32 s17, s9, 0
    s_mov_b32 s18, 4460544
    s_mov_b32 s19, 0x00020000
    s_add_u32 s20, s8, 26279936
    s_addc_u32 s21, s9, 0
    s_mov_b32 s22, 3244032
    s_mov_b32 s23, 0x00020000
    s_mov_b32 s24, s10
    s_mov_b32 s25, s11
    s_mov_b32 s26, 3145728
    s_mov_b32 s27, 0x00020000
    s_add_u32 s28, s8, 25231360
    s_addc_u32 s29, s9, 0
    s_mov_b32 s30, 185856
    s_mov_b32 s31, 0x00020000
    s_mov_b32 s32, s4
    s_mov_b32 s33, s5
    s_mov_b32 s34, 3145728
    s_mov_b32 s35, 0x00020000
    s_mov_b32 s56, s8
    s_mov_b32 s57, s9
    s_mov_b32 s58, 36864
    s_mov_b32 s59, 0x00020000
    s_add_u32 s60, s8, 30474240
    s_addc_u32 s61, s9, 0
    s_mov_b32 s62, 98304
    s_mov_b32 s63, 0x00020000
    s_mul_i32 s38, s77, 96
    v_and_b32 v176, 1, v2
    v_lshlrev_b32 v176, 5, v176
    v_lshrrev_b32 v178, 1, v2
    v_lshl_add_u32 v176, v178, 4, v176
    v_add_u32 v176, s38, v176
    v_lshlrev_b32 v177, 3, v2
    v_add_u32 v177, s38, v177
    s_mul_i32 s39, s76, 48
    s_add_u32 s51, s39, s46
    s_lshl_b32 s52, s41, 10
    s_sub_u32 s52, s52, 32
    s_lshl_b32 s53, s41, 5
    s_cmp_eq_u32 s43, 0
    s_cselect_b32 s52, s53, s52
    v_add_u32 v228, s51, v3
    v_add_u32 v230, s52, v228
    v_mul_u32_u24 v230, 1536, v230
    v_add_u32 v232, v230, v177
    v_cmp_ge_u32 vcc, s54, v228
    v_mov_b32 v229, 0x7ffffff
    s_nop 0
    v_cndmask_b32 v230, v229, v230, vcc
    v_add_u32 v188, v230, v176
    v_add_u32 v191, v230, v177
    v_add_u32 v228, s51, v3
    v_add_u32 v228, 16, v228
    v_add_u32 v230, s52, v228
    v_mul_u32_u24 v230, 1536, v230
    v_add_u32 v233, v230, v177
    v_cmp_ge_u32 vcc, s54, v228
    v_mov_b32 v229, 0x7ffffff
    s_nop 0
    v_cndmask_b32 v230, v229, v230, vcc
    v_add_u32 v189, v230, v176
    v_add_u32 v192, v230, v177
    v_add_u32 v228, s51, v3
    v_add_u32 v228, 32, v228
    v_add_u32 v230, s52, v228
    v_mul_u32_u24 v230, 1536, v230
    v_add_u32 v234, v230, v177
    v_cmp_ge_u32 vcc, s54, v228
    v_mov_b32 v229, 0x7ffffff
    s_nop 0
    v_cndmask_b32 v230, v229, v230, vcc
    s_cmp_eq_u32 s76, 1
    s_cselect_b32 s38, 0x7ffffff, 0
    v_add_u32 v230, s38, v230
    v_add_u32 v190, v230, v176
    v_add_u32 v193, v230, v177
    s_mul_i32 s53, s41, 9216
    s_mul_i32 s38, s44, 384
    s_add_u32 s53, s53, s38
    s_mul_i32 s38, s77, 192
    s_add_u32 s53, s53, s38
    s_add_u32 s53, s53, 6144
    v_lshlrev_b32 v231, 4, v2
    s_mul_i32 s39, s76, 192
    s_add_u32 s39, s39, 147456
    v_lshlrev_b32 v197, 2, v3
    v_add_u32 v197, s39, v197
    s_mov_b32 s70, 0
    s_mov_b32 s71, 0
    v_add_u32 v12, s70, v8
    v_add_u32 v13, s71, v8
    v_add_u32 v14, s70, v9
    v_add_u32 v15, s70, v10
    v_add_u32 v16, s70, v11
    v_add_u32 v17, s71, v9
    v_add_u32 v18, s71, v10
    v_add_u32 v19, s71, v11
    s_barrier
    ds_read_b128 v[20:23], v13 offset:0
    ds_read_b128 v[24:27], v13 offset:3072
    ds_read_b128 v[28:31], v13 offset:6144
    ds_read_b64_tr_b16 v[44:45], v17 offset:0
    ds_read_b64_tr_b16 v[46:47], v17 offset:1536
    ds_read_b64_tr_b16 v[48:49], v18 offset:0
    ds_read_b64_tr_b16 v[50:51], v18 offset:1536
    ds_read_b64_tr_b16 v[52:53], v19 offset:0
    ds_read_b64_tr_b16 v[54:55], v19 offset:1536
    buffer_load_dwordx4 v[216:219], v231, s[56:59], s53 offen offset:0
    buffer_load_dwordx4 v[220:223], v231, s[56:59], s53 offen offset:64
    buffer_load_dwordx4 v[224:227], v231, s[56:59], s53 offen offset:128
    buffer_load_dwordx2 v[198:199], v232, s[32:35], s47 offen offset:0
    buffer_load_dwordx2 v[200:201], v232, s[32:35], s47 offen offset:32
    buffer_load_dwordx2 v[202:203], v232, s[32:35], s47 offen offset:64
    buffer_load_dwordx2 v[204:205], v233, s[32:35], s47 offen offset:0
    buffer_load_dwordx2 v[206:207], v233, s[32:35], s47 offen offset:32
    buffer_load_dwordx2 v[208:209], v233, s[32:35], s47 offen offset:64
    buffer_load_dwordx2 v[210:211], v234, s[32:35], s47 offen offset:0
    buffer_load_dwordx2 v[212:213], v234, s[32:35], s47 offen offset:32
    buffer_load_dwordx2 v[214:215], v234, s[32:35], s47 offen offset:64
    s_mov_b32 s71, 36864
    s_mov_b32 s74, 0
L_fo_cl:
    s_barrier
    v_add_u32 v12, s70, v8
    v_add_u32 v13, s71, v8
    v_add_u32 v14, s70, v9
    v_add_u32 v15, s70, v10
    v_add_u32 v16, s70, v11
    v_add_u32 v17, s71, v9
    v_add_u32 v18, s71, v10
    v_add_u32 v19, s71, v11
    ds_read_b32 v194, v197 offset:0
    ds_read_b32 v195, v197 offset:64
    ds_read_b32 v196, v197 offset:128
    v_add_u32 v197, 384, v197
    s_waitcnt lgkmcnt(0)
    v_mfma_f32_16x16x32_bf16 v[68:71], v[44:47], v[20:23], 0
    ds_read_b128 v[32:35], v12 offset:64
    v_mfma_f32_16x16x32_bf16 v[72:75], v[48:51], v[20:23], 0
    ds_read_b128 v[36:39], v12 offset:3136
    v_mfma_f32_16x16x32_bf16 v[76:79], v[52:55], v[20:23], 0
    ds_read_b128 v[40:43], v12 offset:6208
    v_fmac_f32 v104, v194, v140
    v_fmac_f32 v105, v194, v141
    v_mfma_f32_16x16x32_bf16 v[80:83], v[44:47], v[24:27], 0
    ds_read_b64_tr_b16 v[56:57], v14 offset:6144
    v_fmac_f32 v106, v194, v142
    v_mfma_f32_16x16x32_bf16 v[84:87], v[48:51], v[24:27], 0
    ds_read_b64_tr_b16 v[58:59], v14 offset:7680
    v_fmac_f32 v107, v194, v143
    v_fmac_f32 v108, v194, v144
    v_mfma_f32_16x16x32_bf16 v[88:91], v[52:55], v[24:27], 0
    ds_read_b64_tr_b16 v[60:61], v15 offset:6144
    v_fmac_f32 v109, v194, v145
    v_mfma_f32_16x16x32_bf16 v[92:95], v[44:47], v[28:31], 0
    ds_read_b64_tr_b16 v[62:63], v15 offset:7680
    v_fmac_f32 v110, v194, v146
    v_fmac_f32 v111, v194, v147
    v_mfma_f32_16x16x32_bf16 v[96:99], v[48:51], v[28:31], 0
    ds_read_b64_tr_b16 v[64:65], v16 offset:6144
    v_fmac_f32 v112, v194, v148
    v_mfma_f32_16x16x32_bf16 v[100:103], v[52:55], v[28:31], 0
    ds_read_b64_tr_b16 v[66:67], v16 offset:7680
    v_fmac_f32 v113, v194, v149
    v_fmac_f32 v114, v194, v150
    s_waitcnt lgkmcnt(0)
    v_mfma_f32_16x16x32_bf16 v[68:71], v[56:59], v[32:35], v[68:71]
    ds_read_b128 v[20:23], v12 offset:128
    v_fmac_f32 v115, v194, v151
    v_mfma_f32_16x16x32_bf16 v[72:75], v[60:63], v[32:35], v[72:75]
    ds_read_b128 v[24:27], v12 offset:3200
    v_fmac_f32 v116, v195, v152
    v_mfma_f32_16x16x32_bf16 v[76:79], v[64:67], v[32:35], v[76:79]
    ds_read_b128 v[28:31], v12 offset:6272
    v_fmac_f32 v117, v195, v153
    v_fmac_f32 v118, v195, v154
    v_mfma_f32_16x16x32_bf16 v[80:83], v[56:59], v[36:39], v[80:83]
    ds_read_b64_tr_b16 v[44:45], v14 offset:12288
    v_fmac_f32 v119, v195, v155
    v_mfma_f32_16x16x32_bf16 v[84:87], v[60:63], v[36:39], v[84:87]
    ds_read_b64_tr_b16 v[46:47], v14 offset:13824
    v_fmac_f32 v120, v195, v156
    v_fmac_f32 v121, v195, v157
    v_mfma_f32_16x16x32_bf16 v[88:91], v[64:67], v[36:39], v[88:91]
    ds_read_b64_tr_b16 v[48:49], v15 offset:12288
    v_fmac_f32 v122, v195, v158
    v_mfma_f32_16x16x32_bf16 v[92:95], v[56:59], v[40:43], v[92:95]
    ds_read_b64_tr_b16 v[50:51], v15 offset:13824
    v_fmac_f32 v123, v195, v159
    v_fmac_f32 v124, v195, v160
    v_mfma_f32_16x16x32_bf16 v[96:99], v[60:63], v[40:43], v[96:99]
    ds_read_b64_tr_b16 v[52:53], v16 offset:12288
    v_fmac_f32 v125, v195, v161
    v_mfma_f32_16x16x32_bf16 v[100:103], v[64:67], v[40:43], v[100:103]
    ds_read_b64_tr_b16 v[54:55], v16 offset:13824
    v_fmac_f32 v126, v195, v162
    v_fmac_f32 v127, v195, v163
    s_waitcnt lgkmcnt(0)
    v_mfma_f32_16x16x32_bf16 v[68:71], v[44:47], v[20:23], v[68:71]
    ds_read_b128 v[32:35], v13 offset:0
    v_fmac_f32 v128, v196, v164
    v_mfma_f32_16x16x32_bf16 v[72:75], v[48:51], v[20:23], v[72:75]
    ds_read_b128 v[36:39], v13 offset:3072
    v_fmac_f32 v129, v196, v165
    v_mfma_f32_16x16x32_bf16 v[76:79], v[52:55], v[20:23], v[76:79]
    ds_read_b128 v[40:43], v13 offset:6144
    v_fmac_f32 v130, v196, v166
    v_fmac_f32 v131, v196, v167
    v_mfma_f32_16x16x32_bf16 v[80:83], v[44:47], v[24:27], v[80:83]
    ds_read_b64_tr_b16 v[56:57], v17 offset:0
    v_fmac_f32 v132, v196, v168
    v_mfma_f32_16x16x32_bf16 v[84:87], v[48:51], v[24:27], v[84:87]
    ds_read_b64_tr_b16 v[58:59], v17 offset:1536
    v_fmac_f32 v133, v196, v169
    v_fmac_f32 v134, v196, v170
    v_mfma_f32_16x16x32_bf16 v[88:91], v[52:55], v[24:27], v[88:91]
    ds_read_b64_tr_b16 v[60:61], v18 offset:0
    v_fmac_f32 v135, v196, v171
    v_mfma_f32_16x16x32_bf16 v[92:95], v[44:47], v[28:31], v[92:95]
    ds_read_b64_tr_b16 v[62:63], v18 offset:1536
    v_fmac_f32 v136, v196, v172
    v_fmac_f32 v137, v196, v173
    v_mfma_f32_16x16x32_bf16 v[96:99], v[48:51], v[28:31], v[96:99]
    ds_read_b64_tr_b16 v[64:65], v19 offset:0
    v_fmac_f32 v138, v196, v174
    v_mfma_f32_16x16x32_bf16 v[100:103], v[52:55], v[28:31], v[100:103]
    ds_read_b64_tr_b16 v[66:67], v19 offset:1536
    v_fmac_f32 v139, v196, v175
    s_mov_b32 s70, s71
    s_add_u32 s71, s71, 36864
    s_cmp_ge_u32 s71, 147456
    s_cselect_b32 s71, 0, s71
    s_add_u32 s74, s74, 1
    s_cmp_lt_u32 s74, 11
    s_cbranch_scc0 L_fo_cx
    s_barrier
    v_add_u32 v12, s70, v8
    v_add_u32 v13, s71, v8
    v_add_u32 v14, s70, v9
    v_add_u32 v15, s70, v10
    v_add_u32 v16, s70, v11
    v_add_u32 v17, s71, v9
    v_add_u32 v18, s71, v10
    v_add_u32 v19, s71, v11
    ds_read_b32 v194, v197 offset:0
    ds_read_b32 v195, v197 offset:64
    ds_read_b32 v196, v197 offset:128
    v_add_u32 v197, 384, v197
    s_waitcnt lgkmcnt(0)
    v_mfma_f32_16x16x32_bf16 v[140:143], v[56:59], v[32:35], 0
    ds_read_b128 v[20:23], v12 offset:64
    v_mfma_f32_16x16x32_bf16 v[144:147], v[60:63], v[32:35], 0
    ds_read_b128 v[24:27], v12 offset:3136
    v_mfma_f32_16x16x32_bf16 v[148:151], v[64:67], v[32:35], 0
    ds_read_b128 v[28:31], v12 offset:6208
    v_fmac_f32 v104, v194, v68
    v_fmac_f32 v105, v194, v69
    v_mfma_f32_16x16x32_bf16 v[152:155], v[56:59], v[36:39], 0
    ds_read_b64_tr_b16 v[44:45], v14 offset:6144
    v_fmac_f32 v106, v194, v70
    v_mfma_f32_16x16x32_bf16 v[156:159], v[60:63], v[36:39], 0
    ds_read_b64_tr_b16 v[46:47], v14 offset:7680
    v_fmac_f32 v107, v194, v71
    v_fmac_f32 v108, v194, v72
    v_mfma_f32_16x16x32_bf16 v[160:163], v[64:67], v[36:39], 0
    ds_read_b64_tr_b16 v[48:49], v15 offset:6144
    v_fmac_f32 v109, v194, v73
    v_mfma_f32_16x16x32_bf16 v[164:167], v[56:59], v[40:43], 0
    ds_read_b64_tr_b16 v[50:51], v15 offset:7680
    v_fmac_f32 v110, v194, v74
    v_fmac_f32 v111, v194, v75
    v_mfma_f32_16x16x32_bf16 v[168:171], v[60:63], v[40:43], 0
    ds_read_b64_tr_b16 v[52:53], v16 offset:6144
    v_fmac_f32 v112, v194, v76
    v_mfma_f32_16x16x32_bf16 v[172:175], v[64:67], v[40:43], 0
    ds_read_b64_tr_b16 v[54:55], v16 offset:7680
    v_fmac_f32 v113, v194, v77
    v_fmac_f32 v114, v194, v78
    s_waitcnt lgkmcnt(0)
    v_mfma_f32_16x16x32_bf16 v[140:143], v[44:47], v[20:23], v[140:143]
    ds_read_b128 v[32:35], v12 offset:128
    v_fmac_f32 v115, v194, v79
    v_mfma_f32_16x16x32_bf16 v[144:147], v[48:51], v[20:23], v[144:147]
    ds_read_b128 v[36:39], v12 offset:3200
    v_fmac_f32 v116, v195, v80
    v_mfma_f32_16x16x32_bf16 v[148:151], v[52:55], v[20:23], v[148:151]
    ds_read_b128 v[40:43], v12 offset:6272
    v_fmac_f32 v117, v195, v81
    v_fmac_f32 v118, v195, v82
    v_mfma_f32_16x16x32_bf16 v[152:155], v[44:47], v[24:27], v[152:155]
    ds_read_b64_tr_b16 v[56:57], v14 offset:12288
    v_fmac_f32 v119, v195, v83
    v_mfma_f32_16x16x32_bf16 v[156:159], v[48:51], v[24:27], v[156:159]
    ds_read_b64_tr_b16 v[58:59], v14 offset:13824
    v_fmac_f32 v120, v195, v84
    v_fmac_f32 v121, v195, v85
    v_mfma_f32_16x16x32_bf16 v[160:163], v[52:55], v[24:27], v[160:163]
    ds_read_b64_tr_b16 v[60:61], v15 offset:12288
    v_fmac_f32 v122, v195, v86
    v_mfma_f32_16x16x32_bf16 v[164:167], v[44:47], v[28:31], v[164:167]
    ds_read_b64_tr_b16 v[62:63], v15 offset:13824
    v_fmac_f32 v123, v195, v87
    v_fmac_f32 v124, v195, v88
    v_mfma_f32_16x16x32_bf16 v[168:171], v[48:51], v[28:31], v[168:171]
    ds_read_b64_tr_b16 v[64:65], v16 offset:12288
    v_fmac_f32 v125, v195, v89
    v_mfma_f32_16x16x32_bf16 v[172:175], v[52:55], v[28:31], v[172:175]
    ds_read_b64_tr_b16 v[66:67], v16 offset:13824
    v_fmac_f32 v126, v195, v90
    v_fmac_f32 v127, v195, v91
    s_waitcnt lgkmcnt(0)
    v_mfma_f32_16x16x32_bf16 v[140:143], v[56:59], v[32:35], v[140:143]
    ds_read_b128 v[20:23], v13 offset:0
    v_fmac_f32 v128, v196, v92
    v_mfma_f32_16x16x32_bf16 v[144:147], v[60:63], v[32:35], v[144:147]
    ds_read_b128 v[24:27], v13 offset:3072
    v_fmac_f32 v129, v196, v93
    v_mfma_f32_16x16x32_bf16 v[148:151], v[64:67], v[32:35], v[148:151]
    ds_read_b128 v[28:31], v13 offset:6144
    v_fmac_f32 v130, v196, v94
    v_fmac_f32 v131, v196, v95
    v_mfma_f32_16x16x32_bf16 v[152:155], v[56:59], v[36:39], v[152:155]
    ds_read_b64_tr_b16 v[44:45], v17 offset:0
    v_fmac_f32 v132, v196, v96
    v_mfma_f32_16x16x32_bf16 v[156:159], v[60:63], v[36:39], v[156:159]
    ds_read_b64_tr_b16 v[46:47], v17 offset:1536
    v_fmac_f32 v133, v196, v97
    v_fmac_f32 v134, v196, v98
    v_mfma_f32_16x16x32_bf16 v[160:163], v[64:67], v[36:39], v[160:163]
    ds_read_b64_tr_b16 v[48:49], v18 offset:0
    v_fmac_f32 v135, v196, v99
    v_mfma_f32_16x16x32_bf16 v[164:167], v[56:59], v[40:43], v[164:167]
    ds_read_b64_tr_b16 v[50:51], v18 offset:1536
    v_fmac_f32 v136, v196, v100
    v_fmac_f32 v137, v196, v101
    v_mfma_f32_16x16x32_bf16 v[168:171], v[60:63], v[40:43], v[168:171]
    ds_read_b64_tr_b16 v[52:53], v19 offset:0
    v_fmac_f32 v138, v196, v102
    v_mfma_f32_16x16x32_bf16 v[172:175], v[64:67], v[40:43], v[172:175]
    ds_read_b64_tr_b16 v[54:55], v19 offset:1536
    v_fmac_f32 v139, v196, v103
    s_mov_b32 s70, s71
    s_add_u32 s71, s71, 36864
    s_cmp_ge_u32 s71, 147456
    s_cselect_b32 s71, 0, s71
    s_add_u32 s74, s74, 1
    s_cmp_lt_u32 s74, 11
    s_cbranch_scc1 L_fo_cl
L_fo_cx:
    s_waitcnt lgkmcnt(0)
    s_nop 9
    ds_read_b32 v194, v197 offset:0
    ds_read_b32 v195, v197 offset:64
    ds_read_b32 v196, v197 offset:128
    v_add_u32 v197, 384, v197
    s_waitcnt lgkmcnt(0)
    v_fmac_f32 v104, v194, v68
    v_fmac_f32 v105, v194, v69
    v_fmac_f32 v106, v194, v70
    v_fmac_f32 v107, v194, v71
    v_fmac_f32 v108, v194, v72
    v_fmac_f32 v109, v194, v73
    v_fmac_f32 v110, v194, v74
    v_fmac_f32 v111, v194, v75
    v_fmac_f32 v112, v194, v76
    v_fmac_f32 v113, v194, v77
    v_fmac_f32 v114, v194, v78
    v_fmac_f32 v115, v194, v79
    v_fmac_f32 v116, v195, v80
    v_fmac_f32 v117, v195, v81
    v_fmac_f32 v118, v195, v82
    v_fmac_f32 v119, v195, v83
    v_fmac_f32 v120, v195, v84
    v_fmac_f32 v121, v195, v85
    v_fmac_f32 v122, v195, v86
    v_fmac_f32 v123, v195, v87
    v_fmac_f32 v124, v195, v88
    v_fmac_f32 v125, v195, v89
    v_fmac_f32 v126, v195, v90
    v_fmac_f32 v127, v195, v91
    v_fmac_f32 v128, v196, v92
    v_fmac_f32 v129, v196, v93
    v_fmac_f32 v130, v196, v94
    v_fmac_f32 v131, v196, v95
    v_fmac_f32 v132, v196, v96
    v_fmac_f32 v133, v196, v97
    v_fmac_f32 v134, v196, v98
    v_fmac_f32 v135, v196, v99
    v_fmac_f32 v136, v196, v100
    v_fmac_f32 v137, v196, v101
    v_fmac_f32 v138, v196, v102
    v_fmac_f32 v139, v196, v103
    s_cmp_eq_u32 s43, 0
    s_cbranch_scc1 L_fo_txt
    s_waitcnt vmcnt(0)
    v_lshlrev_b32 v180, 16, v198
    v_and_b32 v181, 0xffff0000, v198
    v_fma_f32 v104, v104, v216, v180
    v_fma_f32 v105, v105, v217, v181
    v_lshlrev_b32 v180, 16, v199
    v_and_b32 v181, 0xffff0000, v199
    v_fma_f32 v106, v106, v218, v180
    v_fma_f32 v107, v107, v219, v181
    v_lshlrev_b32 v180, 16, v200
    v_and_b32 v181, 0xffff0000, v200
    v_fma_f32 v108, v108, v220, v180
    v_fma_f32 v109, v109, v221, v181
    v_lshlrev_b32 v180, 16, v201
    v_and_b32 v181, 0xffff0000, v201
    v_fma_f32 v110, v110, v222, v180
    v_fma_f32 v111, v111, v223, v181
    v_lshlrev_b32 v180, 16, v202
    v_and_b32 v181, 0xffff0000, v202
    v_fma_f32 v112, v112, v224, v180
    v_fma_f32 v113, v113, v225, v181
    v_lshlrev_b32 v180, 16, v203
    v_and_b32 v181, 0xffff0000, v203
    v_fma_f32 v114, v114, v226, v180
    v_fma_f32 v115, v115, v227, v181
    s_nop 0
    v_cvt_pk_bf16_f32 v180, v104, v105
    v_cvt_pk_bf16_f32 v181, v106, v107
    v_cvt_pk_bf16_f32 v182, v108, v109
    v_cvt_pk_bf16_f32 v183, v110, v111
    s_nop 1
    v_permlane16_swap_b32 v180, v182
    v_permlane16_swap_b32 v181, v183
    buffer_store_dwordx4 v[180:183], v188, s[24:27], s47 offen offset:0
    v_cvt_pk_bf16_f32 v184, v112, v113
    v_cvt_pk_bf16_f32 v185, v114, v115
    buffer_store_dwordx2 v[184:185], v191, s[24:27], s47 offen offset:64
    s_nop 1
    v_lshlrev_b32 v180, 16, v204
    v_and_b32 v181, 0xffff0000, v204
    v_fma_f32 v116, v116, v216, v180
    v_fma_f32 v117, v117, v217, v181
    v_lshlrev_b32 v180, 16, v205
    v_and_b32 v181, 0xffff0000, v205
    v_fma_f32 v118, v118, v218, v180
    v_fma_f32 v119, v119, v219, v181
    v_lshlrev_b32 v180, 16, v206
    v_and_b32 v181, 0xffff0000, v206
    v_fma_f32 v120, v120, v220, v180
    v_fma_f32 v121, v121, v221, v181
    v_lshlrev_b32 v180, 16, v207
    v_and_b32 v181, 0xffff0000, v207
    v_fma_f32 v122, v122, v222, v180
    v_fma_f32 v123, v123, v223, v181
    v_lshlrev_b32 v180, 16, v208
    v_and_b32 v181, 0xffff0000, v208
    v_fma_f32 v124, v124, v224, v180
    v_fma_f32 v125, v125, v225, v181
    v_lshlrev_b32 v180, 16, v209
    v_and_b32 v181, 0xffff0000, v209
    v_fma_f32 v126, v126, v226, v180
    v_fma_f32 v127, v127, v227, v181
    s_nop 0
    v_cvt_pk_bf16_f32 v180, v116, v117
    v_cvt_pk_bf16_f32 v181, v118, v119
    v_cvt_pk_bf16_f32 v182, v120, v121
    v_cvt_pk_bf16_f32 v183, v122, v123
    s_nop 1
    v_permlane16_swap_b32 v180, v182
    v_permlane16_swap_b32 v181, v183
    buffer_store_dwordx4 v[180:183], v189, s[24:27], s47 offen offset:0
    v_cvt_pk_bf16_f32 v184, v124, v125
    v_cvt_pk_bf16_f32 v185, v126, v127
    buffer_store_dwordx2 v[184:185], v192, s[24:27], s47 offen offset:64
    s_nop 1
    v_lshlrev_b32 v180, 16, v210
    v_and_b32 v181, 0xffff0000, v210
    v_fma_f32 v128, v128, v216, v180
    v_fma_f32 v129, v129, v217, v181
    v_lshlrev_b32 v180, 16, v211
    v_and_b32 v181, 0xffff0000, v211
    v_fma_f32 v130, v130, v218, v180
    v_fma_f32 v131, v131, v219, v181
    v_lshlrev_b32 v180, 16, v212
    v_and_b32 v181, 0xffff0000, v212
    v_fma_f32 v132, v132, v220, v180
    v_fma_f32 v133, v133, v221, v181
    v_lshlrev_b32 v180, 16, v213
    v_and_b32 v181, 0xffff0000, v213
    v_fma_f32 v134, v134, v222, v180
    v_fma_f32 v135, v135, v223, v181
    v_lshlrev_b32 v180, 16, v214
    v_and_b32 v181, 0xffff0000, v214
    v_fma_f32 v136, v136, v224, v180
    v_fma_f32 v137, v137, v225, v181
    v_lshlrev_b32 v180, 16, v215
    v_and_b32 v181, 0xffff0000, v215
    v_fma_f32 v138, v138, v226, v180
    v_fma_f32 v139, v139, v227, v181
    s_nop 0
    v_cvt_pk_bf16_f32 v180, v128, v129
    v_cvt_pk_bf16_f32 v181, v130, v131
    v_cvt_pk_bf16_f32 v182, v132, v133
    v_cvt_pk_bf16_f32 v183, v134, v135
    s_nop 1
    v_permlane16_swap_b32 v180, v182
    v_permlane16_swap_b32 v181, v183
    buffer_store_dwordx4 v[180:183], v190, s[24:27], s47 offen offset:0
    v_cvt_pk_bf16_f32 v184, v136, v137
    v_cvt_pk_bf16_f32 v185, v138, v139
    buffer_store_dwordx2 v[184:185], v193, s[24:27], s47 offen offset:64
    s_nop 1
    s_endpgm
L_fo_txt:
    v_cvt_pk_bf16_f32 v180, v104, v105
    v_cvt_pk_bf16_f32 v181, v106, v107
    v_cvt_pk_bf16_f32 v182, v108, v109
    v_cvt_pk_bf16_f32 v183, v110, v111
    s_nop 1
    v_permlane16_swap_b32 v180, v182
    v_permlane16_swap_b32 v181, v183
    buffer_store_dwordx4 v[180:183], v188, s[60:63], s47 offen offset:0
    v_cvt_pk_bf16_f32 v184, v112, v113
    v_cvt_pk_bf16_f32 v185, v114, v115
    buffer_store_dwordx2 v[184:185], v191, s[60:63], s47 offen offset:64
    v_cvt_pk_bf16_f32 v180, v116, v117
    v_cvt_pk_bf16_f32 v181, v118, v119
    v_cvt_pk_bf16_f32 v182, v120, v121
    v_cvt_pk_bf16_f32 v183, v122, v123
    s_nop 1
    v_permlane16_swap_b32 v180, v182
    v_permlane16_swap_b32 v181, v183
    buffer_store_dwordx4 v[180:183], v189, s[60:63], s47 offen offset:0
    v_cvt_pk_bf16_f32 v184, v124, v125
    v_cvt_pk_bf16_f32 v185, v126, v127
    buffer_store_dwordx2 v[184:185], v192, s[60:63], s47 offen offset:64
    s_endpgm
L_fo_loader:
    s_sub_u32 s75, s36, 4
    s_lshl_b32 s75, s75, 10
    s_lshr_b32 s37, s75, 4
    v_add_u32 v3, s37, v1
    v_mul_u32_u24 v6, 43691, v3
    v_lshrrev_b32 v6, 19, v6
    v_mul_u32_u24 v7, 12, v6
    v_sub_u32 v5, v3, v7
    v_lshrrev_b32 v7, 2, v6
    v_sub_u32 v7, 0, v7
    v_and_b32 v7, 3, v7
    v_xor_b32 v7, v5, v7
    v_lshlrev_b32 v16, 4, v7
    v_mov_b32 v4, v6
    v_add_u32 v4, s46, v4
    v_min_u32 v4, s54, v4
    v_mul_u32_u24 v4, 192, v4
    v_add_u32 v4, s55, v4
    v_add_u32 v16, v16, v4
    v_add_u32 v3, s37, v1
    v_add_u32 v3, 256, v3
    v_mul_u32_u24 v6, 43691, v3
    v_lshrrev_b32 v6, 19, v6
    v_mul_u32_u24 v7, 12, v6
    v_sub_u32 v5, v3, v7
    v_lshrrev_b32 v7, 2, v6
    v_sub_u32 v7, 0, v7
    v_and_b32 v7, 3, v7
    v_xor_b32 v7, v5, v7
    v_lshlrev_b32 v17, 4, v7
    v_mov_b32 v4, v6
    v_add_u32 v4, s46, v4
    v_min_u32 v4, s54, v4
    v_mul_u32_u24 v4, 192, v4
    v_add_u32 v4, s55, v4
    v_add_u32 v17, v17, v4
    v_add_u32 v3, s37, v1
    v_add_u32 v3, 512, v3
    v_mul_u32_u24 v6, 43691, v3
    v_lshrrev_b32 v6, 19, v6
    v_mul_u32_u24 v7, 12, v6
    v_sub_u32 v5, v3, v7
    v_lshrrev_b32 v7, 2, v6
    v_sub_u32 v7, 0, v7
    v_and_b32 v7, 3, v7
    v_xor_b32 v7, v5, v7
    v_lshlrev_b32 v18, 4, v7
    v_mov_b32 v4, v6
    v_add_u32 v4, s46, v4
    v_min_u32 v4, s54, v4
    v_mul_u32_u24 v4, 192, v4
    v_add_u32 v4, s55, v4
    v_add_u32 v18, v18, v4
    v_add_u32 v3, s37, v1
    v_add_u32 v3, 768, v3
    v_mul_u32_u24 v6, 43691, v3
    v_lshrrev_b32 v6, 19, v6
    v_mul_u32_u24 v7, 12, v6
    v_sub_u32 v5, v3, v7
    v_lshrrev_b32 v7, 2, v6
    v_sub_u32 v7, 0, v7
    v_and_b32 v7, 3, v7
    v_xor_b32 v7, v5, v7
    v_lshlrev_b32 v19, 4, v7
    v_mov_b32 v4, v6
    v_add_u32 v4, s46, v4
    v_min_u32 v4, s54, v4
    v_mul_u32_u24 v4, 192, v4
    v_add_u32 v4, s55, v4
    v_add_u32 v19, v19, v4
    s_cmp_lt_u32 s75, 3072
    s_cselect_b32 s38, 0, 0x40000000
    v_add_u32 v19, s38, v19
    v_add_u32 v3, s37, v1
    v_mul_u32_u24 v6, 43691, v3
    v_lshrrev_b32 v6, 19, v6
    v_mul_u32_u24 v7, 12, v6
    v_sub_u32 v5, v3, v7
    v_lshrrev_b32 v7, 1, v5
    v_bfe_u32 v20, v6, 2, 1
    v_sub_u32 v7, v7, v20
    v_add_u32 v20, 6, v7
    v_min_u32 v7, v7, v20
    v_lshlrev_b32 v7, 5, v7
    v_and_b32 v5, 1, v5
    v_lshl_add_u32 v20, v5, 4, v7
    v_and_b32 v4, 0xfffffff3, v6
    v_bfe_u32 v5, v6, 2, 1
    v_bfe_u32 v7, v6, 3, 1
    v_lshl_or_b32 v4, v5, 3, v4
    v_lshl_or_b32 v4, v7, 2, v4
    v_mul_u32_u24 v4, 192, v4
    v_add_u32 v4, s48, v4
    v_add_u32 v20, v20, v4
    v_add_u32 v3, s37, v1
    v_add_u32 v3, 256, v3
    v_mul_u32_u24 v6, 43691, v3
    v_lshrrev_b32 v6, 19, v6
    v_mul_u32_u24 v7, 12, v6
    v_sub_u32 v5, v3, v7
    v_lshrrev_b32 v7, 1, v5
    v_bfe_u32 v21, v6, 2, 1
    v_sub_u32 v7, v7, v21
    v_add_u32 v21, 6, v7
    v_min_u32 v7, v7, v21
    v_lshlrev_b32 v7, 5, v7
    v_and_b32 v5, 1, v5
    v_lshl_add_u32 v21, v5, 4, v7
    v_and_b32 v4, 0xfffffff3, v6
    v_bfe_u32 v5, v6, 2, 1
    v_bfe_u32 v7, v6, 3, 1
    v_lshl_or_b32 v4, v5, 3, v4
    v_lshl_or_b32 v4, v7, 2, v4
    v_mul_u32_u24 v4, 192, v4
    v_add_u32 v4, s48, v4
    v_add_u32 v21, v21, v4
    v_add_u32 v3, s37, v1
    v_add_u32 v3, 512, v3
    v_mul_u32_u24 v6, 43691, v3
    v_lshrrev_b32 v6, 19, v6
    v_mul_u32_u24 v7, 12, v6
    v_sub_u32 v5, v3, v7
    v_lshrrev_b32 v7, 1, v5
    v_bfe_u32 v22, v6, 2, 1
    v_sub_u32 v7, v7, v22
    v_add_u32 v22, 6, v7
    v_min_u32 v7, v7, v22
    v_lshlrev_b32 v7, 5, v7
    v_and_b32 v5, 1, v5
    v_lshl_add_u32 v22, v5, 4, v7
    v_and_b32 v4, 0xfffffff3, v6
    v_bfe_u32 v5, v6, 2, 1
    v_bfe_u32 v7, v6, 3, 1
    v_lshl_or_b32 v4, v5, 3, v4
    v_lshl_or_b32 v4, v7, 2, v4
    v_mul_u32_u24 v4, 192, v4
    v_add_u32 v4, s48, v4
    v_add_u32 v22, v22, v4
    v_add_u32 v3, s37, v1
    v_add_u32 v3, 768, v3
    v_mul_u32_u24 v6, 43691, v3
    v_lshrrev_b32 v6, 19, v6
    v_mul_u32_u24 v7, 12, v6
    v_sub_u32 v5, v3, v7
    v_lshrrev_b32 v7, 1, v5
    v_bfe_u32 v23, v6, 2, 1
    v_sub_u32 v7, v7, v23
    v_add_u32 v23, 6, v7
    v_min_u32 v7, v7, v23
    v_lshlrev_b32 v7, 5, v7
    v_and_b32 v5, 1, v5
    v_lshl_add_u32 v23, v5, 4, v7
    v_and_b32 v4, 0xfffffff3, v6
    v_bfe_u32 v5, v6, 2, 1
    v_bfe_u32 v7, v6, 3, 1
    v_lshl_or_b32 v4, v5, 3, v4
    v_lshl_or_b32 v4, v7, 2, v4
    v_mul_u32_u24 v4, 192, v4
    v_add_u32 v4, s48, v4
    v_add_u32 v23, v23, v4
    v_add_u32 v3, s37, v1
    v_add_u32 v3, 1024, v3
    v_mul_u32_u24 v6, 43691, v3
    v_lshrrev_b32 v6, 19, v6
    v_mul_u32_u24 v7, 12, v6
    v_sub_u32 v5, v3, v7
    v_lshrrev_b32 v7, 1, v5
    v_bfe_u32 v24, v6, 2, 1
    v_sub_u32 v7, v7, v24
    v_add_u32 v24, 6, v7
    v_min_u32 v7, v7, v24
    v_lshlrev_b32 v7, 5, v7
    v_and_b32 v5, 1, v5
    v_lshl_add_u32 v24, v5, 4, v7
    v_and_b32 v4, 0xfffffff3, v6
    v_bfe_u32 v5, v6, 2, 1
    v_bfe_u32 v7, v6, 3, 1
    v_lshl_or_b32 v4, v5, 3, v4
    v_lshl_or_b32 v4, v7, 2, v4
    v_mul_u32_u24 v4, 192, v4
    v_add_u32 v4, s48, v4
    v_add_u32 v24, v24, v4
    s_cmp_lt_u32 s75, 2048
    s_cselect_b32 s38, 0, 0x40000000
    v_add_u32 v24, s38, v24
    s_waitcnt lgkmcnt(0)
    s_add_u32 s16, s8, 16842752
    s_addc_u32 s17, s9, 0
    s_mov_b32 s18, 4460544
    s_mov_b32 s19, 0x00020000
    s_add_u32 s20, s8, 26279936
    s_addc_u32 s21, s9, 0
    s_mov_b32 s22, 3244032
    s_mov_b32 s23, 0x00020000
    s_mov_b32 s24, s10
    s_mov_b32 s25, s11
    s_mov_b32 s26, 3145728
    s_mov_b32 s27, 0x00020000
    s_add_u32 s28, s8, 25231360
    s_addc_u32 s29, s9, 0
    s_mov_b32 s30, 185856
    s_mov_b32 s31, 0x00020000
    s_mov_b32 s32, s4
    s_mov_b32 s33, s5
    s_mov_b32 s34, 3145728
    s_mov_b32 s35, 0x00020000
    s_mov_b32 s56, s8
    s_mov_b32 s57, s9
    s_mov_b32 s58, 36864
    s_mov_b32 s59, 0x00020000
    s_add_u32 s60, s8, 30474240
    s_addc_u32 s61, s9, 0
    s_mov_b32 s62, 98304
    s_mov_b32 s63, 0x00020000
    s_lshr_b32 s38, s75, 4
    v_add_u32 v64, s38, v1
    v_lshlrev_b32 v69, 2, v64
    v_add_u32 v69, 147456, v69
    v_add_u32 v64, s46, v64
    v_min_u32 v64, s54, v64
    v_lshlrev_b32 v64, 2, v64
    s_mov_b32 s50, s49
    s_add_u32 s39, s50, 92928
    buffer_load_dword v40, v64, s[28:31], s50 offen
    buffer_load_dword v52, v64, s[28:31], s39 offen
    s_add_u32 s50, s50, 4224
    s_add_u32 s39, s50, 92928
    buffer_load_dword v41, v64, s[28:31], s50 offen
    buffer_load_dword v53, v64, s[28:31], s39 offen
    s_add_u32 s50, s50, 4224
    s_add_u32 s39, s50, 92928
    buffer_load_dword v42, v64, s[28:31], s50 offen
    buffer_load_dword v54, v64, s[28:31], s39 offen
    s_add_u32 s50, s50, 4224
    s_add_u32 s39, s50, 92928
    buffer_load_dword v43, v64, s[28:31], s50 offen
    buffer_load_dword v55, v64, s[28:31], s39 offen
    s_add_u32 s50, s50, 4224
    s_add_u32 s39, s50, 92928
    buffer_load_dword v44, v64, s[28:31], s50 offen
    buffer_load_dword v56, v64, s[28:31], s39 offen
    s_add_u32 s50, s50, 4224
    s_add_u32 s39, s50, 92928
    buffer_load_dword v45, v64, s[28:31], s50 offen
    buffer_load_dword v57, v64, s[28:31], s39 offen
    s_add_u32 s50, s50, 4224
    s_add_u32 s39, s50, 92928
    buffer_load_dword v46, v64, s[28:31], s50 offen
    buffer_load_dword v58, v64, s[28:31], s39 offen
    s_add_u32 s50, s50, 4224
    s_add_u32 s39, s50, 92928
    buffer_load_dword v47, v64, s[28:31], s50 offen
    buffer_load_dword v59, v64, s[28:31], s39 offen
    s_add_u32 s50, s50, 4224
    s_add_u32 s39, s50, 92928
    buffer_load_dword v48, v64, s[28:31], s50 offen
    buffer_load_dword v60, v64, s[28:31], s39 offen
    s_add_u32 s50, s50, 4224
    s_add_u32 s39, s50, 92928
    buffer_load_dword v49, v64, s[28:31], s50 offen
    buffer_load_dword v61, v64, s[28:31], s39 offen
    s_add_u32 s50, s50, 4224
    s_add_u32 s39, s50, 92928
    buffer_load_dword v50, v64, s[28:31], s50 offen
    buffer_load_dword v62, v64, s[28:31], s39 offen
    s_add_u32 s50, s50, 4224
    s_mov_b32 s70, s75
    s_mul_i32 s72, s78, 202752
    s_mul_i32 s73, s78, 18432
    s_mov_b32 s74, 0
L_fo_ld0:
    s_add_u32 m0, s70, 0
    s_nop 0
    buffer_load_dwordx4 v16, s[16:19], s72 offen lds
    s_add_u32 m0, s70, 4096
    s_nop 0
    buffer_load_dwordx4 v17, s[16:19], s72 offen lds
    s_add_u32 m0, s70, 8192
    s_nop 0
    buffer_load_dwordx4 v18, s[16:19], s72 offen lds
    s_add_u32 m0, s70, 12288
    s_nop 0
    buffer_load_dwordx4 v19, s[16:19], s72 offen lds
    s_add_u32 m0, s70, 16384
    s_nop 0
    buffer_load_dwordx4 v20, s[20:23], s73 offen lds
    s_add_u32 m0, s70, 20480
    s_nop 0
    buffer_load_dwordx4 v21, s[20:23], s73 offen lds
    s_add_u32 m0, s70, 24576
    s_nop 0
    buffer_load_dwordx4 v22, s[20:23], s73 offen lds
    s_add_u32 m0, s70, 28672
    s_nop 0
    buffer_load_dwordx4 v23, s[20:23], s73 offen lds
    s_add_u32 m0, s70, 32768
    s_nop 0
    buffer_load_dwordx4 v24, s[20:23], s73 offen lds
    s_add_u32 s72, s72, 202752
    s_add_u32 s73, s73, 18432
    s_cmp_ge_u32 s72, 2230272
    s_cselect_b32 s72, 0, s72
    s_cselect_b32 s73, 0, s73
    s_add_u32 s70, s70, 36864
    s_cmp_ge_u32 s70, 147456
    s_cselect_b32 s38, 147456, 0
    s_sub_u32 s70, s70, s38
    s_add_u32 s74, s74, 1
    s_cmp_lt_u32 s74, 3
    s_cbranch_scc1 L_fo_ld0
    s_waitcnt vmcnt(18)
    s_barrier
    s_cmp_ge_u32 s75, 2048
    s_cbranch_scc1 L_fo_nofac
    v_max3_f32 v65, v40, v41, v42
    v_max3_f32 v65, v65, v43, v44
    v_max3_f32 v65, v65, v45, v46
    v_max3_f32 v65, v65, v47, v48
    v_max3_f32 v65, v65, v49, v50
    v_sub_f32 v40, v40, v65
    v_sub_f32 v41, v41, v65
    v_sub_f32 v42, v42, v65
    v_sub_f32 v43, v43, v65
    v_sub_f32 v44, v44, v65
    v_sub_f32 v45, v45, v65
    v_sub_f32 v46, v46, v65
    v_sub_f32 v47, v47, v65
    v_sub_f32 v48, v48, v65
    v_sub_f32 v49, v49, v65
    v_sub_f32 v50, v50, v65
    v_exp_f32 v40, v40
    v_exp_f32 v41, v41
    v_exp_f32 v42, v42
    v_exp_f32 v43, v43
    v_exp_f32 v44, v44
    v_exp_f32 v45, v45
    v_exp_f32 v46, v46
    v_exp_f32 v47, v47
    v_exp_f32 v48, v48
    v_exp_f32 v49, v49
    v_exp_f32 v50, v50
    s_nop 0
    v_mul_f32 v66, v40, v52
    v_fmac_f32 v66, v41, v53
    v_fmac_f32 v66, v42, v54
    v_fmac_f32 v66, v43, v55
    v_fmac_f32 v66, v44, v56
    v_fmac_f32 v66, v45, v57
    v_fmac_f32 v66, v46, v58
    v_fmac_f32 v66, v47, v59
    v_fmac_f32 v66, v48, v60
    v_fmac_f32 v66, v49, v61
    v_fmac_f32 v66, v50, v62
    v_rcp_f32 v66, v66
    v_mov_b32 v67, 0
    s_lshr_b32 s38, s75, 4
    v_add_u32 v65, s38, v1
    v_cmp_gt_u32 vcc, 96, v65
    s_and_saveexec_b64 s[52:53], vcc
    ds_write_b32 v69, v67
    v_mul_f32 v40, v40, v66
    ds_write_b32 v69, v40 offset:384
    v_mul_f32 v41, v41, v66
    ds_write_b32 v69, v41 offset:768
    v_mul_f32 v42, v42, v66
    ds_write_b32 v69, v42 offset:1152
    v_mul_f32 v43, v43, v66
    ds_write_b32 v69, v43 offset:1536
    v_mul_f32 v44, v44, v66
    ds_write_b32 v69, v44 offset:1920
    v_mul_f32 v45, v45, v66
    ds_write_b32 v69, v45 offset:2304
    v_mul_f32 v46, v46, v66
    ds_write_b32 v69, v46 offset:2688
    v_mul_f32 v47, v47, v66
    ds_write_b32 v69, v47 offset:3072
    v_mul_f32 v48, v48, v66
    ds_write_b32 v69, v48 offset:3456
    v_mul_f32 v49, v49, v66
    ds_write_b32 v69, v49 offset:3840
    v_mul_f32 v50, v50, v66
    ds_write_b32 v69, v50 offset:4224
    s_mov_b64 exec, s[52:53]
    s_waitcnt lgkmcnt(0)
L_fo_nofac:
L_fo_ld:
    s_waitcnt vmcnt(9)
    s_barrier
    s_cmp_ge_u32 s74, 11
    s_cselect_b32 s18, 0, s18
    s_cselect_b32 s22, 0, s22
    s_add_u32 m0, s70, 0
    s_nop 0
    buffer_load_dwordx4 v16, s[16:19], s72 offen lds
    s_add_u32 m0, s70, 4096
    s_nop 0
    buffer_load_dwordx4 v17, s[16:19], s72 offen lds
    s_add_u32 m0, s70, 8192
    s_nop 0
    buffer_load_dwordx4 v18, s[16:19], s72 offen lds
    s_add_u32 m0, s70, 12288
    s_nop 0
    buffer_load_dwordx4 v19, s[16:19], s72 offen lds
    s_add_u32 m0, s70, 16384
    s_nop 0
    buffer_load_dwordx4 v20, s[20:23], s73 offen lds
    s_add_u32 m0, s70, 20480
    s_nop 0
    buffer_load_dwordx4 v21, s[20:23], s73 offen lds
    s_add_u32 m0, s70, 24576
    s_nop 0
    buffer_load_dwordx4 v22, s[20:23], s73 offen lds
    s_add_u32 m0, s70, 28672
    s_nop 0
    buffer_load_dwordx4 v23, s[20:23], s73 offen lds
    s_add_u32 m0, s70, 32768
    s_nop 0
    buffer_load_dwordx4 v24, s[20:23], s73 offen lds
    s_add_u32 s72, s72, 202752
    s_add_u32 s73, s73, 18432
    s_cmp_ge_u32 s72, 2230272
    s_cselect_b32 s72, 0, s72
    s_cselect_b32 s73, 0, s73
    s_add_u32 s70, s70, 36864
    s_cmp_ge_u32 s70, 147456
    s_cselect_b32 s38, 147456, 0
    s_sub_u32 s70, s70, s38
    s_add_u32 s74, s74, 1
    s_cmp_lt_u32 s74, 14
    s_cbranch_scc1 L_fo_ld
    s_waitcnt vmcnt(0)
    s_endpgm
L_fo_t2:
    s_load_dwordx2 s[4:5], s[0:1], 8
    s_load_dwordx2 s[12:13], s[0:1], 48
    s_load_dwordx4 s[8:11], s[0:1], 72
    s_load_dwordx2 s[14:15], s[0:1], 88
    s_cmp_ge_u32 s2, 24
    s_cselect_b32 s41, 1, 0
    s_mul_i32 s42, s41, 24
    s_sub_u32 s44, s2, s42
    s_lshl_b32 s47, s44, 6
    s_mul_i32 s45, s41, 1056

    v_lshrrev_b32 v2, 6, v0
    v_and_b32 v1, 63, v0
    s_nop 0
    v_readfirstlane_b32 s36, v2
    s_nop 3
    v_lshrrev_b32 v2, 4, v1
    v_and_b32 v3, 15, v1
    s_lshr_b32 s76, s36, 1
    s_and_b32 s76, s76, 1
    s_and_b32 s77, s36, 1
    v_lshrrev_b32 v7, 2, v1
    v_bfe_u32 v8, v1, 1, 1
    v_bfe_u32 v9, v7, 2, 1
    v_xor_b32 v8, v8, v9
    v_and_b32 v9, 1, v1
    v_lshlrev_b32 v9, 4, v9
    v_lshl_add_u32 v8, v8, 5, v9
    v_and_b32 v9, 0xfffffff3, v7
    v_bfe_u32 v10, v7, 2, 1
    v_bfe_u32 v11, v7, 3, 1
    v_lshl_or_b32 v9, v10, 3, v9
    v_lshl_or_b32 v9, v11, 2, v9
    v_lshl_add_u32 v16, v9, 7, v8
    v_mul_u32_u24 v9, 1536, v9
    v_add_u32 v12, v8, v9
    s_lshl_b32 s37, s36, 6
    v_add_u32 v6, s37, v1
    v_mul_u32_u24 v8, 43691, v6
    v_lshrrev_b32 v8, 19, v8
    v_mul_u32_u24 v10, 12, v8
    v_sub_u32 v7, v6, v10
    v_lshrrev_b32 v10, 2, v8
    v_sub_u32 v10, 0, v10
    v_and_b32 v10, 3, v10
    v_xor_b32 v10, v7, v10
    v_lshlrev_b32 v15, 4, v10
    v_mov_b32 v9, v8
    v_mul_u32_u24 v9, 192, v9
    v_add_u32 v15, v15, v9
    s_lshl_b32 s38, s76, 4
    v_add_u32 v4, s38, v3
    v_lshlrev_b32 v13, 2, v4
    v_lshrrev_b32 v5, 2, v3
    v_sub_u32 v5, 0, v5
    v_and_b32 v5, 3, v5
    v_xor_b32 v5, v5, v2
    v_lshlrev_b32 v5, 4, v5
    v_mul_u32_u24 v6, 192, v4
    v_add_u32 v20, v5, v6
    v_add_u32 v20, 67584, v20
    v_and_b32 v5, 7, v1
    v_xor_b32 v5, v5, v2
    v_lshlrev_b32 v5, 4, v5
    v_lshl_add_u32 v18, v4, 7, v5
    v_add_u32 v18, 49152, v18
    v_xor_b32 v19, 64, v18
    s_lshl_b32 s38, s41, 5
    v_add_u32 v26, s38, v4
    v_mul_u32_u24 v26, 1536, v26
    s_lshl_b32 s39, s77, 5
    v_lshl_add_u32 v27, v2, 3, v26
    v_add_u32 v27, s39, v27
    v_lshrrev_b32 v4, 1, v2
    v_lshlrev_b32 v4, 4, v4
    v_and_b32 v5, 1, v2
    v_lshl_add_u32 v4, v5, 2, v4
    v_lshrrev_b32 v6, 2, v3
    v_add_u32 v4, v4, v6
    v_lshlrev_b32 v4, 6, v4
    v_xor_b32 v5, s77, v5
    v_lshl_add_u32 v4, v5, 5, v4
    v_and_b32 v5, 3, v1
    v_lshl_add_u32 v21, v5, 3, v4
    v_add_u32 v22, 65536, v21
    s_waitcnt lgkmcnt(0)
    s_add_u32 s16, s14, 16842752
    s_addc_u32 s17, s15, 0
    s_mov_b32 s18, 4460544
    s_mov_b32 s19, 0x00020000
    s_add_u32 s20, s14, 12648448
    s_addc_u32 s21, s15, 0
    s_mov_b32 s22, 3244032
    s_mov_b32 s23, 0x00020000
    s_add_u32 s28, s14, 25231360
    s_addc_u32 s29, s15, 0
    s_mov_b32 s30, 185856
    s_mov_b32 s31, 0x00020000
    s_lshl_b32 s50, s45, 7
    s_lshr_b32 s38, s44, 1
    s_mul_i32 s38, s38, 270336
    s_add_u32 s50, s50, s38
    s_and_b32 s38, s44, 1
    s_lshl_b32 s38, s38, 6
    s_add_u32 s50, s50, s38
    s_lshl_b32 s38, s36, 11
    s_add_u32 s50, s50, s38
    s_mul_i32 s51, s36, 24576
    s_lshl_b32 s38, s36, 10
    s_mul_i32 s55, s41, 2230272
    s_cmp_ge_u32 s36, 6
    s_cbranch_scc1 L_t2_noe0
    s_add_u32 m0, s38, 67584
    s_nop 0
    buffer_load_dwordx4 v15, s[16:19], s55 offen lds
L_t2_noe0:
    s_add_u32 s55, s55, 202752
    s_add_u32 m0, s38, 0
    s_nop 0
    buffer_load_dwordx4 v16, s[20:23], s50 offen lds
    s_add_u32 s50, s50, 16384
    s_cmp_ge_u32 s36, 6
    s_cbranch_scc1 L_t2_noe1
    s_add_u32 m0, s38, 73728
    s_nop 0
    buffer_load_dwordx4 v15, s[16:19], s55 offen lds
L_t2_noe1:
    s_add_u32 s55, s55, 202752
    s_add_u32 m0, s38, 8192
    s_nop 0
    buffer_load_dwordx4 v16, s[20:23], s50 offen lds
    s_add_u32 s50, s50, 16384
    s_cmp_ge_u32 s36, 6
    s_cbranch_scc1 L_t2_noe2
    s_add_u32 m0, s38, 79872
    s_nop 0
    buffer_load_dwordx4 v15, s[16:19], s55 offen lds
L_t2_noe2:
    s_add_u32 s55, s55, 202752
    s_add_u32 m0, s38, 16384
    s_nop 0
    buffer_load_dwordx4 v16, s[20:23], s50 offen lds
    s_add_u32 s50, s50, 16384
    s_cmp_ge_u32 s36, 6
    s_cbranch_scc1 L_t2_noe3
    s_add_u32 m0, s38, 86016
    s_nop 0
    buffer_load_dwordx4 v15, s[16:19], s55 offen lds
L_t2_noe3:
    s_add_u32 s55, s55, 202752
    s_add_u32 m0, s38, 24576
    s_nop 0
    buffer_load_dwordx4 v16, s[20:23], s50 offen lds
    s_add_u32 s50, s50, 16384
    s_cmp_ge_u32 s36, 6
    s_cbranch_scc1 L_t2_noe4
    s_add_u32 m0, s38, 92160
    s_nop 0
    buffer_load_dwordx4 v15, s[16:19], s55 offen lds
L_t2_noe4:
    s_add_u32 s55, s55, 202752
    s_add_u32 m0, s38, 32768
    s_nop 0
    buffer_load_dwordx4 v16, s[20:23], s50 offen lds
    s_add_u32 s50, s50, 16384
    s_cmp_ge_u32 s36, 6
    s_cbranch_scc1 L_t2_noe5
    s_add_u32 m0, s38, 98304
    s_nop 0
    buffer_load_dwordx4 v15, s[16:19], s55 offen lds
L_t2_noe5:
    s_add_u32 s55, s55, 202752
    s_add_u32 m0, s38, 40960
    s_nop 0
    buffer_load_dwordx4 v16, s[20:23], s50 offen lds
    s_add_u32 s50, s50, 16384
    s_cmp_ge_u32 s36, 6
    s_cbranch_scc1 L_t2_noe6
    s_add_u32 m0, s38, 104448
    s_nop 0
    buffer_load_dwordx4 v15, s[16:19], s55 offen lds
L_t2_noe6:
    s_add_u32 s55, s55, 202752
    s_add_u32 m0, s38, 49152
    s_nop 0
    buffer_load_dwordx4 v16, s[20:23], s50 offen lds
    s_add_u32 s50, s50, 16384
    s_cmp_ge_u32 s36, 6
    s_cbranch_scc1 L_t2_noe7
    s_add_u32 m0, s38, 110592
    s_nop 0
    buffer_load_dwordx4 v15, s[16:19], s55 offen lds
L_t2_noe7:
    s_add_u32 s55, s55, 202752
    s_add_u32 m0, s38, 57344
    s_nop 0
    buffer_load_dwordx4 v16, s[20:23], s50 offen lds
    s_add_u32 s50, s50, 16384
    s_cmp_ge_u32 s36, 6
    s_cbranch_scc1 L_t2_noe8
    s_add_u32 m0, s38, 116736
    s_nop 0
    buffer_load_dwordx4 v15, s[16:19], s55 offen lds
L_t2_noe8:
    s_add_u32 s55, s55, 202752
    s_cmp_lt_u32 s36, 2
    s_cbranch_scc0 L_t2_skip8
    s_add_u32 m0, s38, 65536
    s_nop 0
    buffer_load_dwordx4 v16, s[20:23], s50 offen lds
    s_add_u32 s50, s50, 16384
L_t2_skip8:
    s_cmp_ge_u32 s36, 6
    s_cbranch_scc1 L_t2_noe9
    s_add_u32 m0, s38, 122880
    s_nop 0
    buffer_load_dwordx4 v15, s[16:19], s55 offen lds
L_t2_noe9:
    s_add_u32 s55, s55, 202752
    s_cmp_ge_u32 s36, 6
    s_cbranch_scc1 L_t2_noe10
    s_add_u32 m0, s38, 129024
    s_nop 0
    buffer_load_dwordx4 v15, s[16:19], s55 offen lds
L_t2_noe10:
    s_add_u32 s55, s55, 202752
    s_mul_i32 s50, s41, 46464
    s_add_u32 s39, s50, 92928
    buffer_load_dword v40, v13, s[28:31], s50 offen
    buffer_load_dword v52, v13, s[28:31], s39 offen
    s_add_u32 s50, s50, 4224
    s_add_u32 s39, s50, 92928
    buffer_load_dword v41, v13, s[28:31], s50 offen
    buffer_load_dword v53, v13, s[28:31], s39 offen
    s_add_u32 s50, s50, 4224
    s_add_u32 s39, s50, 92928
    buffer_load_dword v42, v13, s[28:31], s50 offen
    buffer_load_dword v54, v13, s[28:31], s39 offen
    s_add_u32 s50, s50, 4224
    s_add_u32 s39, s50, 92928
    buffer_load_dword v43, v13, s[28:31], s50 offen
    buffer_load_dword v55, v13, s[28:31], s39 offen
    s_add_u32 s50, s50, 4224
    s_add_u32 s39, s50, 92928
    buffer_load_dword v44, v13, s[28:31], s50 offen
    buffer_load_dword v56, v13, s[28:31], s39 offen
    s_add_u32 s50, s50, 4224
    s_add_u32 s39, s50, 92928
    buffer_load_dword v45, v13, s[28:31], s50 offen
    buffer_load_dword v57, v13, s[28:31], s39 offen
    s_add_u32 s50, s50, 4224
    s_add_u32 s39, s50, 92928
    buffer_load_dword v46, v13, s[28:31], s50 offen
    buffer_load_dword v58, v13, s[28:31], s39 offen
    s_add_u32 s50, s50, 4224
    s_add_u32 s39, s50, 92928
    buffer_load_dword v47, v13, s[28:31], s50 offen
    buffer_load_dword v59, v13, s[28:31], s39 offen
    s_add_u32 s50, s50, 4224
    s_add_u32 s39, s50, 92928
    buffer_load_dword v48, v13, s[28:31], s50 offen
    buffer_load_dword v60, v13, s[28:31], s39 offen
    s_add_u32 s50, s50, 4224
    s_add_u32 s39, s50, 92928
    buffer_load_dword v49, v13, s[28:31], s50 offen
    buffer_load_dword v61, v13, s[28:31], s39 offen
    s_add_u32 s50, s50, 4224
    s_add_u32 s39, s50, 92928
    buffer_load_dword v50, v13, s[28:31], s50 offen
    buffer_load_dword v62, v13, s[28:31], s39 offen
    s_add_u32 s50, s50, 4224
    s_add_u32 s24, s8, 3145728
    s_addc_u32 s25, s9, 0
    s_mov_b32 s26, 98304
    s_mov_b32 s27, 0x00020000
    s_mov_b32 s32, s4
    s_mov_b32 s33, s5
    s_mov_b32 s34, 98304
    s_mov_b32 s35, 0x00020000
    s_mov_b32 s56, s14
    s_mov_b32 s57, s15
    s_mov_b32 s58, 36864
    s_mov_b32 s59, 0x00020000
    s_add_u32 s60, s14, 30474240
    s_addc_u32 s61, s15, 0
    s_mov_b32 s62, 98304
    s_mov_b32 s63, 0x00020000
    s_mov_b32 s64, s12
    s_mov_b32 s65, s13
    s_mov_b32 s66, 1179648
    s_mov_b32 s67, 0x00020000
    s_mov_b32 s68, s10
    s_mov_b32 s69, s11
    s_mov_b32 s70, 256
    s_mov_b32 s71, 0x00020000

    buffer_load_dwordx2 v[28:29], v27, s[32:35], s47 offen
    s_mul_i32 s53, s41, 9216
    s_lshl_b32 s38, s44, 7
    s_add_u32 s53, s53, s38
    s_lshl_b32 s38, s77, 6
    s_add_u32 s53, s53, s38
    s_add_u32 s53, s53, 24576
    v_lshlrev_b32 v30, 4, v2
    buffer_load_dwordx4 v[32:35], v30, s[56:59], s53 offen
    v_add_u32 v4, 0, v0
    v_mul_u32_u24 v5, 43691, v4
    v_lshrrev_b32 v5, 22, v5
    v_mul_u32_u24 v6, 96, v5
    v_sub_u32 v6, v4, v6
    s_lshl_b32 s38, s41, 5
    v_add_u32 v7, s38, v5
    v_mul_u32_u24 v7, 1536, v7
    v_lshl_add_u32 v100, v6, 4, v7
    v_lshrrev_b32 v7, 3, v6
    v_xor_b32 v6, v6, v5
    v_and_b32 v6, 7, v6
    v_lshlrev_b32 v6, 4, v6
    v_lshl_add_u32 v6, v5, 7, v6
    v_lshl_add_u32 v6, v7, 12, v6
    v_add_u32 v106, 49152, v6
    v_add_u32 v4, 512, v0
    v_mul_u32_u24 v5, 43691, v4
    v_lshrrev_b32 v5, 22, v5
    v_mul_u32_u24 v6, 96, v5
    v_sub_u32 v6, v4, v6
    s_lshl_b32 s38, s41, 5
    v_add_u32 v7, s38, v5
    v_mul_u32_u24 v7, 1536, v7
    v_lshl_add_u32 v101, v6, 4, v7
    v_lshrrev_b32 v7, 3, v6
    v_xor_b32 v6, v6, v5
    v_and_b32 v6, 7, v6
    v_lshlrev_b32 v6, 4, v6
    v_lshl_add_u32 v6, v5, 7, v6
    v_lshl_add_u32 v6, v7, 12, v6
    v_add_u32 v107, 49152, v6
    v_add_u32 v4, 1024, v0
    v_mul_u32_u24 v5, 43691, v4
    v_lshrrev_b32 v5, 22, v5
    v_mul_u32_u24 v6, 96, v5
    v_sub_u32 v6, v4, v6
    s_lshl_b32 s38, s41, 5
    v_add_u32 v7, s38, v5
    v_mul_u32_u24 v7, 1536, v7
    v_lshl_add_u32 v102, v6, 4, v7
    v_lshrrev_b32 v7, 3, v6
    v_xor_b32 v6, v6, v5
    v_and_b32 v6, 7, v6
    v_lshlrev_b32 v6, 4, v6
    v_lshl_add_u32 v6, v5, 7, v6
    v_lshl_add_u32 v6, v7, 12, v6
    v_add_u32 v108, 49152, v6
    v_add_u32 v4, 1536, v0
    v_mul_u32_u24 v5, 43691, v4
    v_lshrrev_b32 v5, 22, v5
    v_mul_u32_u24 v6, 96, v5
    v_sub_u32 v6, v4, v6
    s_lshl_b32 s38, s41, 5
    v_add_u32 v7, s38, v5
    v_mul_u32_u24 v7, 1536, v7
    v_lshl_add_u32 v103, v6, 4, v7
    v_lshrrev_b32 v7, 3, v6
    v_xor_b32 v6, v6, v5
    v_and_b32 v6, 7, v6
    v_lshlrev_b32 v6, 4, v6
    v_lshl_add_u32 v6, v5, 7, v6
    v_lshl_add_u32 v6, v7, 12, v6
    v_add_u32 v109, 49152, v6
    v_add_u32 v4, 2048, v0
    v_mul_u32_u24 v5, 43691, v4
    v_lshrrev_b32 v5, 22, v5
    v_mul_u32_u24 v6, 96, v5
    v_sub_u32 v6, v4, v6
    s_lshl_b32 s38, s41, 5
    v_add_u32 v7, s38, v5
    v_mul_u32_u24 v7, 1536, v7
    v_lshl_add_u32 v104, v6, 4, v7
    v_lshrrev_b32 v7, 3, v6
    v_xor_b32 v6, v6, v5
    v_and_b32 v6, 7, v6
    v_lshlrev_b32 v6, 4, v6
    v_lshl_add_u32 v6, v5, 7, v6
    v_lshl_add_u32 v6, v7, 12, v6
    v_add_u32 v110, 49152, v6
    v_add_u32 v4, 2560, v0
    v_mul_u32_u24 v5, 43691, v4
    v_lshrrev_b32 v5, 22, v5
    v_mul_u32_u24 v6, 96, v5
    v_sub_u32 v6, v4, v6
    s_lshl_b32 s38, s41, 5
    v_add_u32 v7, s38, v5
    v_mul_u32_u24 v7, 1536, v7
    v_lshl_add_u32 v105, v6, 4, v7
    v_lshrrev_b32 v7, 3, v6
    v_xor_b32 v6, v6, v5
    v_and_b32 v6, 7, v6
    v_lshlrev_b32 v6, 4, v6
    v_lshl_add_u32 v6, v5, 7, v6
    v_lshl_add_u32 v6, v7, 12, v6
    v_add_u32 v111, 49152, v6
    s_waitcnt vmcnt(0)
    s_barrier
    s_cmp_ge_u32 s36, 4
    s_cbranch_scc1 L_t2_ldw
    v_max3_f32 v64, v40, v41, v42
    v_max3_f32 v64, v64, v43, v44
    v_max3_f32 v64, v64, v45, v46
    v_max3_f32 v64, v64, v47, v48
    v_max3_f32 v64, v64, v49, v50
    v_sub_f32 v40, v40, v64
    v_sub_f32 v41, v41, v64
    v_sub_f32 v42, v42, v64
    v_sub_f32 v43, v43, v64
    v_sub_f32 v44, v44, v64
    v_sub_f32 v45, v45, v64
    v_sub_f32 v46, v46, v64
    v_sub_f32 v47, v47, v64
    v_sub_f32 v48, v48, v64
    v_sub_f32 v49, v49, v64
    v_sub_f32 v50, v50, v64
    v_exp_f32 v40, v40
    v_exp_f32 v41, v41
    v_exp_f32 v42, v42
    v_exp_f32 v43, v43
    v_exp_f32 v44, v44
    v_exp_f32 v45, v45
    v_exp_f32 v46, v46
    v_exp_f32 v47, v47
    v_exp_f32 v48, v48
    v_exp_f32 v49, v49
    v_exp_f32 v50, v50
    s_nop 0
    v_mul_f32 v65, v40, v52
    v_fmac_f32 v65, v41, v53
    v_fmac_f32 v65, v42, v54
    v_fmac_f32 v65, v43, v55
    v_fmac_f32 v65, v44, v56
    v_fmac_f32 v65, v45, v57
    v_fmac_f32 v65, v46, v58
    v_fmac_f32 v65, v47, v59
    v_fmac_f32 v65, v48, v60
    v_fmac_f32 v65, v49, v61
    v_fmac_f32 v65, v50, v62
    v_rcp_f32 v65, v65
    s_nop 0
    v_mul_f32 v40, v40, v65
    v_mul_f32 v41, v41, v65
    v_mul_f32 v42, v42, v65
    v_mul_f32 v43, v43, v65
    v_mul_f32 v44, v44, v65
    v_mul_f32 v45, v45, v65
    v_mul_f32 v46, v46, v65
    v_mul_f32 v47, v47, v65
    v_mul_f32 v48, v48, v65
    v_mul_f32 v49, v49, v65
    v_mul_f32 v50, v50, v65
    v_mov_b32 v76, 0
    v_mov_b32 v77, 0
    v_mov_b32 v78, 0
    v_mov_b32 v79, 0
    ds_read_b128 v[80:83], v20 offset:0
    ds_read_b64_tr_b16 v[84:85], v21 offset:0
    ds_read_b64_tr_b16 v[86:87], v21 offset:512
    ds_read_b128 v[88:91], v20 offset:64
    ds_read_b64_tr_b16 v[92:93], v21 offset:2048
    ds_read_b64_tr_b16 v[94:95], v21 offset:2560
    s_waitcnt lgkmcnt(3)
    v_mfma_f32_16x16x32_bf16 v[68:71], v[84:87], v[80:83], 0
    ds_read_b128 v[80:83], v20 offset:128
    ds_read_b64_tr_b16 v[84:85], v21 offset:4096
    ds_read_b64_tr_b16 v[86:87], v21 offset:4608
    s_waitcnt lgkmcnt(3)
    v_mfma_f32_16x16x32_bf16 v[68:71], v[92:95], v[88:91], v[68:71]
    ds_read_b128 v[88:91], v20 offset:6144
    ds_read_b64_tr_b16 v[92:93], v21 offset:6144
    ds_read_b64_tr_b16 v[94:95], v21 offset:6656
    s_waitcnt lgkmcnt(3)
    v_mfma_f32_16x16x32_bf16 v[68:71], v[84:87], v[80:83], v[68:71]
    ds_read_b128 v[80:83], v20 offset:6208
    ds_read_b64_tr_b16 v[84:85], v21 offset:8192
    ds_read_b64_tr_b16 v[86:87], v21 offset:8704
    s_waitcnt lgkmcnt(3)
    v_mfma_f32_16x16x32_bf16 v[72:75], v[92:95], v[88:91], 0
    ds_read_b128 v[88:91], v20 offset:6272
    ds_read_b64_tr_b16 v[92:93], v21 offset:10240
    ds_read_b64_tr_b16 v[94:95], v21 offset:10752
    s_waitcnt lgkmcnt(3)
    v_mfma_f32_16x16x32_bf16 v[72:75], v[84:87], v[80:83], v[72:75]
    ds_read_b128 v[80:83], v20 offset:12288
    ds_read_b64_tr_b16 v[84:85], v21 offset:12288
    ds_read_b64_tr_b16 v[86:87], v21 offset:12800
    s_waitcnt lgkmcnt(3)
    v_mfma_f32_16x16x32_bf16 v[72:75], v[92:95], v[88:91], v[72:75]
    s_nop 3
    v_fmac_f32 v76, v40, v68
    v_fmac_f32 v77, v40, v69
    v_fmac_f32 v78, v40, v70
    v_fmac_f32 v79, v40, v71
    ds_read_b128 v[88:91], v20 offset:12352
    ds_read_b64_tr_b16 v[92:93], v21 offset:14336
    ds_read_b64_tr_b16 v[94:95], v21 offset:14848
    s_waitcnt lgkmcnt(3)
    v_mfma_f32_16x16x32_bf16 v[68:71], v[84:87], v[80:83], 0
    ds_read_b128 v[80:83], v20 offset:12416
    ds_read_b64_tr_b16 v[84:85], v21 offset:16384
    ds_read_b64_tr_b16 v[86:87], v21 offset:16896
    s_waitcnt lgkmcnt(3)
    v_mfma_f32_16x16x32_bf16 v[68:71], v[92:95], v[88:91], v[68:71]
    ds_read_b128 v[88:91], v20 offset:18432
    ds_read_b64_tr_b16 v[92:93], v21 offset:18432
    ds_read_b64_tr_b16 v[94:95], v21 offset:18944
    s_waitcnt lgkmcnt(3)
    v_mfma_f32_16x16x32_bf16 v[68:71], v[84:87], v[80:83], v[68:71]
    s_nop 3
    v_fmac_f32 v76, v41, v72
    v_fmac_f32 v77, v41, v73
    v_fmac_f32 v78, v41, v74
    v_fmac_f32 v79, v41, v75
    ds_read_b128 v[80:83], v20 offset:18496
    ds_read_b64_tr_b16 v[84:85], v21 offset:20480
    ds_read_b64_tr_b16 v[86:87], v21 offset:20992
    s_waitcnt lgkmcnt(3)
    v_mfma_f32_16x16x32_bf16 v[72:75], v[92:95], v[88:91], 0
    ds_read_b128 v[88:91], v20 offset:18560
    ds_read_b64_tr_b16 v[92:93], v21 offset:22528
    ds_read_b64_tr_b16 v[94:95], v21 offset:23040
    s_waitcnt lgkmcnt(3)
    v_mfma_f32_16x16x32_bf16 v[72:75], v[84:87], v[80:83], v[72:75]
    ds_read_b128 v[80:83], v20 offset:24576
    ds_read_b64_tr_b16 v[84:85], v21 offset:24576
    ds_read_b64_tr_b16 v[86:87], v21 offset:25088
    s_waitcnt lgkmcnt(3)
    v_mfma_f32_16x16x32_bf16 v[72:75], v[92:95], v[88:91], v[72:75]
    s_nop 3
    v_fmac_f32 v76, v42, v68
    v_fmac_f32 v77, v42, v69
    v_fmac_f32 v78, v42, v70
    v_fmac_f32 v79, v42, v71
    ds_read_b128 v[88:91], v20 offset:24640
    ds_read_b64_tr_b16 v[92:93], v21 offset:26624
    ds_read_b64_tr_b16 v[94:95], v21 offset:27136
    s_waitcnt lgkmcnt(3)
    v_mfma_f32_16x16x32_bf16 v[68:71], v[84:87], v[80:83], 0
    ds_read_b128 v[80:83], v20 offset:24704
    ds_read_b64_tr_b16 v[84:85], v21 offset:28672
    ds_read_b64_tr_b16 v[86:87], v21 offset:29184
    s_waitcnt lgkmcnt(3)
    v_mfma_f32_16x16x32_bf16 v[68:71], v[92:95], v[88:91], v[68:71]
    ds_read_b128 v[88:91], v20 offset:30720
    ds_read_b64_tr_b16 v[92:93], v21 offset:30720
    ds_read_b64_tr_b16 v[94:95], v21 offset:31232
    s_waitcnt lgkmcnt(3)
    v_mfma_f32_16x16x32_bf16 v[68:71], v[84:87], v[80:83], v[68:71]
    s_nop 3
    v_fmac_f32 v76, v43, v72
    v_fmac_f32 v77, v43, v73
    v_fmac_f32 v78, v43, v74
    v_fmac_f32 v79, v43, v75
    ds_read_b128 v[80:83], v20 offset:30784
    ds_read_b64_tr_b16 v[84:85], v21 offset:32768
    ds_read_b64_tr_b16 v[86:87], v21 offset:33280
    s_waitcnt lgkmcnt(3)
    v_mfma_f32_16x16x32_bf16 v[72:75], v[92:95], v[88:91], 0
    ds_read_b128 v[88:91], v20 offset:30848
    ds_read_b64_tr_b16 v[92:93], v21 offset:34816
    ds_read_b64_tr_b16 v[94:95], v21 offset:35328
    s_waitcnt lgkmcnt(3)
    v_mfma_f32_16x16x32_bf16 v[72:75], v[84:87], v[80:83], v[72:75]
    ds_read_b128 v[80:83], v20 offset:36864
    ds_read_b64_tr_b16 v[84:85], v21 offset:36864
    ds_read_b64_tr_b16 v[86:87], v21 offset:37376
    s_waitcnt lgkmcnt(3)
    v_mfma_f32_16x16x32_bf16 v[72:75], v[92:95], v[88:91], v[72:75]
    s_nop 3
    v_fmac_f32 v76, v44, v68
    v_fmac_f32 v77, v44, v69
    v_fmac_f32 v78, v44, v70
    v_fmac_f32 v79, v44, v71
    ds_read_b128 v[88:91], v20 offset:36928
    ds_read_b64_tr_b16 v[92:93], v21 offset:38912
    ds_read_b64_tr_b16 v[94:95], v21 offset:39424
    s_waitcnt lgkmcnt(3)
    v_mfma_f32_16x16x32_bf16 v[68:71], v[84:87], v[80:83], 0
    ds_read_b128 v[80:83], v20 offset:36992
    ds_read_b64_tr_b16 v[84:85], v21 offset:40960
    ds_read_b64_tr_b16 v[86:87], v21 offset:41472
    s_waitcnt lgkmcnt(3)
    v_mfma_f32_16x16x32_bf16 v[68:71], v[92:95], v[88:91], v[68:71]
    ds_read_b128 v[88:91], v20 offset:43008
    ds_read_b64_tr_b16 v[92:93], v21 offset:43008
    ds_read_b64_tr_b16 v[94:95], v21 offset:43520
    s_waitcnt lgkmcnt(3)
    v_mfma_f32_16x16x32_bf16 v[68:71], v[84:87], v[80:83], v[68:71]
    s_nop 3
    v_fmac_f32 v76, v45, v72
    v_fmac_f32 v77, v45, v73
    v_fmac_f32 v78, v45, v74
    v_fmac_f32 v79, v45, v75
    ds_read_b128 v[80:83], v20 offset:43072
    ds_read_b64_tr_b16 v[84:85], v21 offset:45056
    ds_read_b64_tr_b16 v[86:87], v21 offset:45568
    s_waitcnt lgkmcnt(3)
    v_mfma_f32_16x16x32_bf16 v[72:75], v[92:95], v[88:91], 0
    ds_read_b128 v[88:91], v20 offset:43136
    ds_read_b64_tr_b16 v[92:93], v21 offset:47104
    ds_read_b64_tr_b16 v[94:95], v21 offset:47616
    s_waitcnt lgkmcnt(3)
    v_mfma_f32_16x16x32_bf16 v[72:75], v[84:87], v[80:83], v[72:75]
    ds_read_b128 v[80:83], v20 offset:49152
    ds_read_b64_tr_b16 v[84:85], v21 offset:49152
    ds_read_b64_tr_b16 v[86:87], v21 offset:49664
    s_waitcnt lgkmcnt(3)
    v_mfma_f32_16x16x32_bf16 v[72:75], v[92:95], v[88:91], v[72:75]
    s_nop 3
    v_fmac_f32 v76, v46, v68
    v_fmac_f32 v77, v46, v69
    v_fmac_f32 v78, v46, v70
    v_fmac_f32 v79, v46, v71
    ds_read_b128 v[88:91], v20 offset:49216
    ds_read_b64_tr_b16 v[92:93], v21 offset:51200
    ds_read_b64_tr_b16 v[94:95], v21 offset:51712
    s_waitcnt lgkmcnt(3)
    v_mfma_f32_16x16x32_bf16 v[68:71], v[84:87], v[80:83], 0
    ds_read_b128 v[80:83], v20 offset:49280
    ds_read_b64_tr_b16 v[84:85], v21 offset:53248
    ds_read_b64_tr_b16 v[86:87], v21 offset:53760
    s_waitcnt lgkmcnt(3)
    v_mfma_f32_16x16x32_bf16 v[68:71], v[92:95], v[88:91], v[68:71]
    ds_read_b128 v[88:91], v20 offset:55296
    ds_read_b64_tr_b16 v[92:93], v21 offset:55296
    ds_read_b64_tr_b16 v[94:95], v21 offset:55808
    s_waitcnt lgkmcnt(3)
    v_mfma_f32_16x16x32_bf16 v[68:71], v[84:87], v[80:83], v[68:71]
    s_nop 3
    v_fmac_f32 v76, v47, v72
    v_fmac_f32 v77, v47, v73
    v_fmac_f32 v78, v47, v74
    v_fmac_f32 v79, v47, v75
    ds_read_b128 v[80:83], v20 offset:55360
    ds_read_b64_tr_b16 v[84:85], v21 offset:57344
    ds_read_b64_tr_b16 v[86:87], v21 offset:57856
    s_waitcnt lgkmcnt(3)
    v_mfma_f32_16x16x32_bf16 v[72:75], v[92:95], v[88:91], 0
    ds_read_b128 v[88:91], v20 offset:55424
    ds_read_b64_tr_b16 v[92:93], v21 offset:59392
    ds_read_b64_tr_b16 v[94:95], v21 offset:59904
    s_waitcnt lgkmcnt(3)
    v_mfma_f32_16x16x32_bf16 v[72:75], v[84:87], v[80:83], v[72:75]
    ds_read_b128 v[80:83], v20 offset:61440
    ds_read_b64_tr_b16 v[84:85], v21 offset:61440
    ds_read_b64_tr_b16 v[86:87], v21 offset:61952
    s_waitcnt lgkmcnt(3)
    v_mfma_f32_16x16x32_bf16 v[72:75], v[92:95], v[88:91], v[72:75]
    s_nop 3
    v_fmac_f32 v76, v48, v68
    v_fmac_f32 v77, v48, v69
    v_fmac_f32 v78, v48, v70
    v_fmac_f32 v79, v48, v71
    ds_read_b128 v[88:91], v20 offset:61504
    ds_read_b64_tr_b16 v[92:93], v21 offset:63488
    ds_read_b64_tr_b16 v[94:95], v21 offset:64000
    s_waitcnt lgkmcnt(3)
    v_mfma_f32_16x16x32_bf16 v[68:71], v[84:87], v[80:83], 0
    ds_read_b128 v[80:83], v20 offset:61568
    ds_read_b64_tr_b16 v[84:85], v22 offset:0
    ds_read_b64_tr_b16 v[86:87], v22 offset:512
    s_waitcnt lgkmcnt(3)
    v_mfma_f32_16x16x32_bf16 v[68:71], v[92:95], v[88:91], v[68:71]
    s_waitcnt lgkmcnt(0)
    v_mfma_f32_16x16x32_bf16 v[68:71], v[84:87], v[80:83], v[68:71]
    s_nop 3
    v_fmac_f32 v76, v49, v72
    v_fmac_f32 v77, v49, v73
    v_fmac_f32 v78, v49, v74
    v_fmac_f32 v79, v49, v75
    s_nop 11
    v_fmac_f32 v76, v50, v68
    v_fmac_f32 v77, v50, v69
    v_fmac_f32 v78, v50, v70
    v_fmac_f32 v79, v50, v71
    v_cvt_pk_bf16_f32 v24, v76, v77
    v_cvt_pk_bf16_f32 v25, v78, v79
    buffer_store_dwordx2 v[24:25], v27, s[60:63], s47 offen sc1
    s_waitcnt vmcnt(0)
L_t2_ldw:
    s_barrier
    s_lshl_b32 s38, s41, 7
    v_mov_b32 v36, s38
    v_mov_b32 v37, 1
    s_cmp_lg_u32 s36, 0
    s_cbranch_scc1 L_t2_nosig
    v_cmp_eq_u32 vcc, 0, v1
    s_and_saveexec_b64 s[52:53], vcc
    buffer_atomic_add v37, v36, s[68:71], 0 offen sc1
    s_mov_b64 exec, s[52:53]
L_t2_nosig:
    s_add_u32 s50, s47, s51
    s_lshl_b32 s38, s36, 10
    s_add_u32 m0, s38, 0
    s_nop 0
    buffer_load_dwordx4 v12, s[64:67], s50 offen lds
    s_add_u32 s50, s50, 196608
    s_add_u32 m0, s38, 8192
    s_nop 0
    buffer_load_dwordx4 v12, s[64:67], s50 offen lds
    s_add_u32 s50, s50, 196608
    s_add_u32 m0, s38, 16384
    s_nop 0
    buffer_load_dwordx4 v12, s[64:67], s50 offen lds
    s_add_u32 s50, s50, 196608
    s_add_u32 m0, s38, 24576
    s_nop 0
    buffer_load_dwordx4 v12, s[64:67], s50 offen lds
    s_add_u32 s50, s50, 196608
    s_add_u32 m0, s38, 32768
    s_nop 0
    buffer_load_dwordx4 v12, s[64:67], s50 offen lds
    s_add_u32 s50, s50, 196608
    s_add_u32 m0, s38, 40960
    s_nop 0
    buffer_load_dwordx4 v12, s[64:67], s50 offen lds
    s_add_u32 s50, s50, 196608
    s_cmp_lg_u32 s36, 0
    s_cbranch_scc1 L_t2_wait_done
L_t2_poll:
    buffer_load_dword v37, v36, s[68:71], 0 offen sc1
    s_waitcnt vmcnt(0)
    v_readfirstlane_b32 s54, v37
    s_nop 3
    s_cmp_ge_u32 s54, 24
    s_cbranch_scc1 L_t2_wait_done
    s_sleep 2
    s_branch L_t2_poll
L_t2_wait_done:
    s_barrier
    buffer_load_dwordx4 v[112:115], v100, s[60:63], 0 offen sc1
    buffer_load_dwordx4 v[116:119], v101, s[60:63], 0 offen sc1
    buffer_load_dwordx4 v[120:123], v102, s[60:63], 0 offen sc1
    buffer_load_dwordx4 v[124:127], v103, s[60:63], 0 offen sc1
    buffer_load_dwordx4 v[128:131], v104, s[60:63], 0 offen sc1
    buffer_load_dwordx4 v[132:135], v105, s[60:63], 0 offen sc1
    s_waitcnt vmcnt(5)
    ds_write_b128 v106, v[112:115]
    s_waitcnt vmcnt(4)
    ds_write_b128 v107, v[116:119]
    s_waitcnt vmcnt(3)
    ds_write_b128 v108, v[120:123]
    s_waitcnt vmcnt(2)
    ds_write_b128 v109, v[124:127]
    s_waitcnt vmcnt(1)
    ds_write_b128 v110, v[128:131]
    s_waitcnt vmcnt(0)
    ds_write_b128 v111, v[132:135]
    s_waitcnt lgkmcnt(0)
    s_barrier
    s_cmp_ge_u32 s36, 4
    s_cbranch_scc1 L_fo_end
    v_mov_b32 v76, 0
    v_mov_b32 v77, 0
    v_mov_b32 v78, 0
    v_mov_b32 v79, 0
    ds_read_b128 v[80:83], v18 offset:0
    ds_read_b64_tr_b16 v[84:85], v21 offset:0
    ds_read_b64_tr_b16 v[86:87], v21 offset:512
    ds_read_b128 v[88:91], v19 offset:0
    ds_read_b64_tr_b16 v[92:93], v21 offset:2048
    ds_read_b64_tr_b16 v[94:95], v21 offset:2560
    s_waitcnt lgkmcnt(3)
    v_mfma_f32_16x16x32_bf16 v[76:79], v[84:87], v[80:83], v[76:79]
    ds_read_b128 v[80:83], v18 offset:4096
    ds_read_b64_tr_b16 v[84:85], v21 offset:4096
    ds_read_b64_tr_b16 v[86:87], v21 offset:4608
    s_waitcnt lgkmcnt(3)
    v_mfma_f32_16x16x32_bf16 v[76:79], v[92:95], v[88:91], v[76:79]
    ds_read_b128 v[88:91], v19 offset:4096
    ds_read_b64_tr_b16 v[92:93], v21 offset:6144
    ds_read_b64_tr_b16 v[94:95], v21 offset:6656
    s_waitcnt lgkmcnt(3)
    v_mfma_f32_16x16x32_bf16 v[76:79], v[84:87], v[80:83], v[76:79]
    ds_read_b128 v[80:83], v18 offset:8192
    ds_read_b64_tr_b16 v[84:85], v21 offset:8192
    ds_read_b64_tr_b16 v[86:87], v21 offset:8704
    s_waitcnt lgkmcnt(3)
    v_mfma_f32_16x16x32_bf16 v[76:79], v[92:95], v[88:91], v[76:79]
    ds_read_b128 v[88:91], v19 offset:8192
    ds_read_b64_tr_b16 v[92:93], v21 offset:10240
    ds_read_b64_tr_b16 v[94:95], v21 offset:10752
    s_waitcnt lgkmcnt(3)
    v_mfma_f32_16x16x32_bf16 v[76:79], v[84:87], v[80:83], v[76:79]
    ds_read_b128 v[80:83], v18 offset:12288
    ds_read_b64_tr_b16 v[84:85], v21 offset:12288
    ds_read_b64_tr_b16 v[86:87], v21 offset:12800
    s_waitcnt lgkmcnt(3)
    v_mfma_f32_16x16x32_bf16 v[76:79], v[92:95], v[88:91], v[76:79]
    ds_read_b128 v[88:91], v19 offset:12288
    ds_read_b64_tr_b16 v[92:93], v21 offset:14336
    ds_read_b64_tr_b16 v[94:95], v21 offset:14848
    s_waitcnt lgkmcnt(3)
    v_mfma_f32_16x16x32_bf16 v[76:79], v[84:87], v[80:83], v[76:79]
    ds_read_b128 v[80:83], v18 offset:16384
    ds_read_b64_tr_b16 v[84:85], v21 offset:16384
    ds_read_b64_tr_b16 v[86:87], v21 offset:16896
    s_waitcnt lgkmcnt(3)
    v_mfma_f32_16x16x32_bf16 v[76:79], v[92:95], v[88:91], v[76:79]
    ds_read_b128 v[88:91], v19 offset:16384
    ds_read_b64_tr_b16 v[92:93], v21 offset:18432
    ds_read_b64_tr_b16 v[94:95], v21 offset:18944
    s_waitcnt lgkmcnt(3)
    v_mfma_f32_16x16x32_bf16 v[76:79], v[84:87], v[80:83], v[76:79]
    ds_read_b128 v[80:83], v18 offset:20480
    ds_read_b64_tr_b16 v[84:85], v21 offset:20480
    ds_read_b64_tr_b16 v[86:87], v21 offset:20992
    s_waitcnt lgkmcnt(3)
    v_mfma_f32_16x16x32_bf16 v[76:79], v[92:95], v[88:91], v[76:79]
    ds_read_b128 v[88:91], v19 offset:20480
    ds_read_b64_tr_b16 v[92:93], v21 offset:22528
    ds_read_b64_tr_b16 v[94:95], v21 offset:23040
    s_waitcnt lgkmcnt(3)
    v_mfma_f32_16x16x32_bf16 v[76:79], v[84:87], v[80:83], v[76:79]
    ds_read_b128 v[80:83], v18 offset:24576
    ds_read_b64_tr_b16 v[84:85], v21 offset:24576
    ds_read_b64_tr_b16 v[86:87], v21 offset:25088
    s_waitcnt lgkmcnt(3)
    v_mfma_f32_16x16x32_bf16 v[76:79], v[92:95], v[88:91], v[76:79]
    ds_read_b128 v[88:91], v19 offset:24576
    ds_read_b64_tr_b16 v[92:93], v21 offset:26624
    ds_read_b64_tr_b16 v[94:95], v21 offset:27136
    s_waitcnt lgkmcnt(3)
    v_mfma_f32_16x16x32_bf16 v[76:79], v[84:87], v[80:83], v[76:79]
    ds_read_b128 v[80:83], v18 offset:28672
    ds_read_b64_tr_b16 v[84:85], v21 offset:28672
    ds_read_b64_tr_b16 v[86:87], v21 offset:29184
    s_waitcnt lgkmcnt(3)
    v_mfma_f32_16x16x32_bf16 v[76:79], v[92:95], v[88:91], v[76:79]
    ds_read_b128 v[88:91], v19 offset:28672
    ds_read_b64_tr_b16 v[92:93], v21 offset:30720
    ds_read_b64_tr_b16 v[94:95], v21 offset:31232
    s_waitcnt lgkmcnt(3)
    v_mfma_f32_16x16x32_bf16 v[76:79], v[84:87], v[80:83], v[76:79]
    ds_read_b128 v[80:83], v18 offset:32768
    ds_read_b64_tr_b16 v[84:85], v21 offset:32768
    ds_read_b64_tr_b16 v[86:87], v21 offset:33280
    s_waitcnt lgkmcnt(3)
    v_mfma_f32_16x16x32_bf16 v[76:79], v[92:95], v[88:91], v[76:79]
    ds_read_b128 v[88:91], v19 offset:32768
    ds_read_b64_tr_b16 v[92:93], v21 offset:34816
    ds_read_b64_tr_b16 v[94:95], v21 offset:35328
    s_waitcnt lgkmcnt(3)
    v_mfma_f32_16x16x32_bf16 v[76:79], v[84:87], v[80:83], v[76:79]
    ds_read_b128 v[80:83], v18 offset:36864
    ds_read_b64_tr_b16 v[84:85], v21 offset:36864
    ds_read_b64_tr_b16 v[86:87], v21 offset:37376
    s_waitcnt lgkmcnt(3)
    v_mfma_f32_16x16x32_bf16 v[76:79], v[92:95], v[88:91], v[76:79]
    ds_read_b128 v[88:91], v19 offset:36864
    ds_read_b64_tr_b16 v[92:93], v21 offset:38912
    ds_read_b64_tr_b16 v[94:95], v21 offset:39424
    s_waitcnt lgkmcnt(3)
    v_mfma_f32_16x16x32_bf16 v[76:79], v[84:87], v[80:83], v[76:79]
    ds_read_b128 v[80:83], v18 offset:40960
    ds_read_b64_tr_b16 v[84:85], v21 offset:40960
    ds_read_b64_tr_b16 v[86:87], v21 offset:41472
    s_waitcnt lgkmcnt(3)
    v_mfma_f32_16x16x32_bf16 v[76:79], v[92:95], v[88:91], v[76:79]
    ds_read_b128 v[88:91], v19 offset:40960
    ds_read_b64_tr_b16 v[92:93], v21 offset:43008
    ds_read_b64_tr_b16 v[94:95], v21 offset:43520
    s_waitcnt lgkmcnt(3)
    v_mfma_f32_16x16x32_bf16 v[76:79], v[84:87], v[80:83], v[76:79]
    ds_read_b128 v[80:83], v18 offset:45056
    ds_read_b64_tr_b16 v[84:85], v21 offset:45056
    ds_read_b64_tr_b16 v[86:87], v21 offset:45568
    s_waitcnt lgkmcnt(3)
    v_mfma_f32_16x16x32_bf16 v[76:79], v[92:95], v[88:91], v[76:79]
    ds_read_b128 v[88:91], v19 offset:45056
    ds_read_b64_tr_b16 v[92:93], v21 offset:47104
    ds_read_b64_tr_b16 v[94:95], v21 offset:47616
    s_waitcnt lgkmcnt(3)
    v_mfma_f32_16x16x32_bf16 v[76:79], v[84:87], v[80:83], v[76:79]
    s_waitcnt lgkmcnt(0)
    v_mfma_f32_16x16x32_bf16 v[76:79], v[92:95], v[88:91], v[76:79]
    s_nop 11
    v_lshlrev_b32 v24, 16, v28
    v_and_b32 v25, 0xffff0000, v28
    v_fma_f32 v76, v76, v32, v24
    v_fma_f32 v77, v77, v33, v25
    v_lshlrev_b32 v24, 16, v29
    v_and_b32 v25, 0xffff0000, v29
    v_fma_f32 v78, v78, v34, v24
    v_fma_f32 v79, v79, v35, v25
    v_cvt_pk_bf16_f32 v24, v76, v77
    v_cvt_pk_bf16_f32 v25, v78, v79
    buffer_store_dwordx2 v[24:25], v27, s[24:27], s47 offen
    s_endpgm
L_fo_end:
    s_endpgm
L_code_end:
.set CODE_BYTES, L_code_end-L_code_begin_next
.section .rodata,"a"
.p2align 6
.amdhsa_kernel mod_kernel
  .amdhsa_next_free_vgpr 88
  .amdhsa_next_free_sgpr 100
  .amdhsa_accum_offset 88
  .amdhsa_group_segment_fixed_size 0
  .amdhsa_kernarg_size 96
  .amdhsa_user_sgpr_count 2
  .amdhsa_user_sgpr_kernarg_segment_ptr 1
  .amdhsa_system_sgpr_workgroup_id_x 1
.end_amdhsa_kernel
.p2align 6
.amdhsa_kernel ln_kernel
  .amdhsa_next_free_vgpr 80
  .amdhsa_next_free_sgpr 100
  .amdhsa_accum_offset 80
  .amdhsa_group_segment_fixed_size 0
  .amdhsa_kernarg_size 96
  .amdhsa_user_sgpr_count 2
  .amdhsa_user_sgpr_kernarg_segment_ptr 1
  .amdhsa_system_sgpr_workgroup_id_x 1
.end_amdhsa_kernel
.p2align 6
.amdhsa_kernel qkv_kernel
  .amdhsa_next_free_vgpr 200
  .amdhsa_next_free_sgpr 100
  .amdhsa_accum_offset 200
  .amdhsa_group_segment_fixed_size 0
  .amdhsa_kernarg_size 96
  .amdhsa_user_sgpr_count 2
  .amdhsa_user_sgpr_kernarg_segment_ptr 1
  .amdhsa_system_sgpr_workgroup_id_x 1
.end_amdhsa_kernel
.p2align 6
.amdhsa_kernel sv_kernel
  .amdhsa_next_free_vgpr 248
  .amdhsa_next_free_sgpr 100
  .amdhsa_accum_offset 248
  .amdhsa_group_segment_fixed_size 0
  .amdhsa_kernarg_size 96
  .amdhsa_user_sgpr_count 2
  .amdhsa_user_sgpr_kernarg_segment_ptr 1
  .amdhsa_system_sgpr_workgroup_id_x 1
.end_amdhsa_kernel
.p2align 6
.amdhsa_kernel fo_kernel
  .amdhsa_next_free_vgpr 240
  .amdhsa_next_free_sgpr 100
  .amdhsa_accum_offset 240
  .amdhsa_group_segment_fixed_size 0
  .amdhsa_kernarg_size 96
  .amdhsa_user_sgpr_count 2
  .amdhsa_user_sgpr_kernarg_segment_ptr 1
  .amdhsa_system_sgpr_workgroup_id_x 1
.end_amdhsa_kernel
```
